```python
import torch

def _softmax(x, axis=-1):
    return torch.softmax(x, dim=axis)
def _gelu(x):
    return torch.nn.functional.gelu(x, approximate="tanh")
def _silu(x):
    return torch.nn.functional.silu(x)
def _sigmoid(x):
    return torch.sigmoid(x)
def _layernorm(x, axis=-1, eps=1e-5):
    m = x.mean(dim=axis, keepdim=True)
    v = x.var(dim=axis, keepdim=True, unbiased=False)
    return (x - m) / torch.sqrt(v + eps)
def _scatter_add(tgt, idx, src, axis=0):
    return tgt.clone().index_add_(axis, idx, src)
def _segment_sum(src, seg, n):
    out = torch.zeros((n,) + src.shape[1:], dtype=src.dtype)
    return out.index_add_(0, seg, src)
def _pad(x, pw):
    flat = tuple(v for pair in reversed(pw) for v in pair)
    return torch.nn.functional.pad(x, flat)

kernel_name = 'parallel_sum__compressed_kv_cla__glu_gated_glu__decode'

def setup_inputs():

    _w = (lambda a: (lambda t: t.to(torch.bfloat16) if t.is_floating_point() else t)(torch.as_tensor(a)))
    def _A_setup():
        B, H, Sq, Sk, D, M = 1, 32, 1, 8192, 128, 576
        Dc = 4 * D
        return {
            "x": _w((lambda *s: torch.randn(*s, dtype=torch.bfloat16) * 0.05)(B, Sq, M)),
            "c_kv": _w((lambda *s: torch.randn(*s, dtype=torch.bfloat16) * 1.6)(B, Sk, Dc)),
            "w_q": _w((lambda *s: torch.randn(*s, dtype=torch.bfloat16) * 3.2)(M, H, D) * (M ** -0.5)),
            "w_uk": _w((lambda *s: torch.randn(*s, dtype=torch.bfloat16) * 3.2)(Dc, H, D) * (Dc ** -0.5)),
            "w_uv": _w((lambda *s: torch.randn(*s, dtype=torch.bfloat16) * 1.6)(Dc, H, D) * (Dc ** -0.5)),
            "w_o": _w((lambda *s: torch.randn(*s, dtype=torch.bfloat16) * 1.6)(H, D, M) * ((H * D) ** -0.5)),
        }
    _A_in = _A_setup()

    def _B_setup():
        B, S, D, F = 1, 1, 576, 4608
        return {
            "x": _w((lambda *s: torch.randn(*s, dtype=torch.bfloat16) * 0.05)(B, S, D)),
            "w_gate": _w((lambda *s: torch.randn(*s, dtype=torch.bfloat16) * 0.2)(D, F)),
            "w_up": _w((lambda *s: torch.randn(*s, dtype=torch.bfloat16) * 0.05)(D, F)),
            "w_down": _w((lambda *s: torch.randn(*s, dtype=torch.bfloat16) * 0.05)(F, D)),
        }
    _B_in = _B_setup()

    return {
        "A_x": _A_in["x"],
        "A_c_kv": _A_in["c_kv"],
        "A_w_q": _A_in["w_q"],
        "A_w_uk": _A_in["w_uk"],
        "A_w_uv": _A_in["w_uv"],
        "A_w_o": _A_in["w_o"],
        "B_x": _B_in["x"],
        "B_w_gate": _B_in["w_gate"],
        "B_w_up": _B_in["w_up"],
        "B_w_down": _B_in["w_down"],
    }

def reference(A_x, A_c_kv, A_w_q, A_w_uk, A_w_uv, A_w_o, B_x, B_w_gate, B_w_up, B_w_down):
    def _A_ref(x, c_kv, w_q, w_uk, w_uv, w_o):
        B, Sq, M = x.shape[0], x.shape[1], x.shape[2]
        Sk = c_kv.shape[1]
        H, D = w_q.shape[1], w_q.shape[2]
        q = torch.einsum("bqm,mhd->bhqd", x, w_q)
        k = torch.einsum("bkc,chd->bhkd", c_kv, w_uk)
        v = torch.einsum("bkc,chd->bhkd", c_kv, w_uv)
        scores = torch.einsum("bhqd,bhkd->bhqk", q, k) * (D ** -0.5)
        off = Sk - Sq
        qi = torch.arange(Sq)[:, None]
        kj = torch.arange(Sk)[None, :]
        cmask = kj <= (qi + off)
        scores = torch.where(cmask[None, None], scores, -1e9)
        p = _softmax(scores, axis=-1)
        ctx = torch.einsum("bhqk,bhkd->bhqd", p, v)
        return torch.einsum("bhqd,hdm->bqm", ctx, w_o)

    def _B_ref(x, w_gate, w_up, w_down):
        g = torch.einsum("bsd,df->bsf", x, w_gate)
        u = torch.einsum("bsd,df->bsf", x, w_up)
        h = _sigmoid(g) * u
        return torch.einsum("bsf,fd->bsd", h, w_down)

    x = A_x
    xn = _layernorm(x, axis=-1)
    return x + _A_ref(xn, A_c_kv, A_w_q, A_w_uk, A_w_uv, A_w_o) + _B_ref(xn, B_w_gate, B_w_up, B_w_down)
```

```asm
; @launch grid=(256,1,1) block=(256,1,1) lds=163840
.amdgcn_target "amdgcn-amd-amdhsa--gfx950"
.text
.globl parallel_sum__compressed_kv_cla__glu_gated_glu__decode_kernel
.p2align 8
.type parallel_sum__compressed_kv_cla__glu_gated_glu__decode_kernel,@function
parallel_sum__compressed_kv_cla__glu_gated_glu__decode_kernel:
L_begin:
    s_cmp_ge_u32 s2, 256
    s_cbranch_scc1 L_end
    s_load_dwordx2 s[32:33], s[0:1], 16
    s_load_dwordx2 s[48:49], s[0:1], 0
    s_load_dwordx16 s[4:19], s[0:1], 0
    s_load_dwordx8 s[20:27], s[0:1], 64
    s_load_dwordx2 s[28:29], s[0:1], 96
    v_lshrrev_b32 v7, 6, v0
    v_and_b32 v1, 63, v0
    v_readfirstlane_b32 s3, v7
    v_lshrrev_b32 v3, 4, v1
    v_lshlrev_b32 v6, 4, v1
    v_lshlrev_b32 v7, 2, v1
    v_and_b32 v13, 0x70, v0
    v_lshrrev_b32 v13, 3, v13
    v_xor_b32 v13, v13, v1
    v_and_b32 v13, 15, v13
    v_lshlrev_b32 v12, 4, v13
    v_lshl_add_u32 v13, v3, 13, v12
    s_and_b32 s53, s2, 7
    s_bfe_u32 s54, s2, 0x20003
    s_lshl2_add_u32 s53, s53, s54
    s_lshr_b32 s54, s2, 5
    s_max_u32 s58, s54, 4
    s_mul_i32 s100, s54, 16
    s_mul_i32 s58, s58, 4
    s_add_u32 s100, s100, s58
    s_sub_u32 s100, s100, 16
    s_add_u32 s30, s100, s3
    s_lshl_b32 s30, s30, 7
    s_add_u32 s30, s30, s53
    s_lshl_b32 s30, s30, 8
    s_lshl_b32 s31, s3, 10
    s_add_u32 m0, s31, 126976
    s_mov_b32 s35, 0x20000
    s_mov_b32 s51, 0x20000
    s_mov_b32 s34, 4718592
    s_movk_i32 s50, 1152
    s_movk_i32 s60, 4096
    s_getpc_b64 s[44:45]
L_pc:
    s_sub_u32 s44, s44, L_pc-L_begin
    s_subb_u32 s45, s45, 0
    s_cmp_lt_u32 s2, 16
    s_cselect_b32 s46, L_end_of_code-L_begin, 0
    s_mov_b32 s47, 0x20000
    s_lshl_b32 s61, s3, 13
    v_lshlrev_b32 v250, 7, v1
    buffer_load_dword v251, v250, s[44:47], s61 offen
    s_waitcnt lgkmcnt(0)
    buffer_load_dwordx4 v[14:17], v6, s[48:51], 0 offen
    buffer_load_dword v18, v7, s[48:51], 0 offen offset:1024
    buffer_load_dwordx4 v13, s[32:35], s30 offen nt lds
    s_add_u32 m0, m0, s60
    s_add_u32 s30, s30, s35
    buffer_load_dwordx4 v13, s[32:35], s30 offen nt lds
    s_add_u32 m0, m0, s60
    s_add_u32 s30, s30, s35
    buffer_load_dwordx4 v13, s[32:35], s30 offen nt lds
    s_add_u32 m0, m0, s60
    s_add_u32 s30, s30, s35
    buffer_load_dwordx4 v13, s[32:35], s30 offen nt lds
    s_add_u32 m0, m0, s60
    s_add_u32 s30, s30, s35
    s_load_dword s52, s[28:29], 0
    v_and_b32 v2, 15, v1
    v_lshrrev_b32 v4, 2, v1
    v_and_b32 v5, 3, v1
    v_lshlrev_b32 v5, 3, v5
    v_lshl_add_u32 v12, v3, 16, v12
    s_lshl_b32 s59, s53, 8
    s_mov_b32 s36, s10
    s_mov_b32 s37, s11
    s_mov_b32 s38, 4194304
    s_mov_b32 s39, 0x20000
    s_mov_b32 s40, s6
    s_mov_b32 s41, s7
    s_mov_b32 s42, 8388608
    s_mov_b32 s43, 0x20000
    s_cmp_ge_u32 s2, 128
    s_cbranch_scc1 L_att_1
    s_lshl_b32 s30, s54, 2
    s_add_u32 s30, s30, s3
    s_lshl_b32 s30, s30, 18
    s_add_u32 s30, s30, s59
    s_lshl_b32 s31, s3, 10
    s_waitcnt vmcnt(4)
    s_mov_b32 m0, s31
    s_add_u32 s31, s31, 4096
    buffer_load_dwordx4 v12, s[36:39], s30 offen nt lds
    s_add_u32 s30, s30, 8192
    s_mov_b32 m0, s31
    s_add_u32 s31, s31, 4096
    buffer_load_dwordx4 v12, s[36:39], s30 offen nt lds
    s_add_u32 s30, s30, 8192
    s_mov_b32 m0, s31
    s_add_u32 s31, s31, 4096
    buffer_load_dwordx4 v12, s[36:39], s30 offen nt lds
    s_add_u32 s30, s30, 8192
    s_mov_b32 m0, s31
    s_add_u32 s31, s31, 4096
    buffer_load_dwordx4 v12, s[36:39], s30 offen nt lds
    s_add_u32 s30, s30, 8192
    s_branch L_att_1_j
L_att_1:
    buffer_load_dwordx4 v13, s[32:35], s30 offen nt lds
    s_add_u32 m0, m0, s60
    s_add_u32 s30, s30, s35
    s_and_b32 s58, s2, 7
    s_bfe_u32 s59, s2, 0x30004
    s_lshl_b32 s59, s59, 3
    s_add_u32 s101, s58, s59
    s_bfe_u32 s59, s2, 0x10003
    s_lshl_b32 s30, s101, 17
    s_lshl_b32 s59, s59, 16
    s_add_u32 s30, s30, s59
    s_lshl_b32 s59, s3, 13
    s_add_u32 s30, s30, s59
    s_mul_i32 s31, s3, 8448
    s_waitcnt vmcnt(5)
L_att_1_j:
    s_mov_b32 s44, s28
    s_mov_b32 s45, s29
    s_mov_b32 s46, 6291456
    s_mov_b32 s47, 0x20000
    s_lshl_b32 s58, s53, 13
    s_add_u32 s58, s58, 4259840
    s_lshl_b32 s59, s54, 10
    s_add_u32 s58, s58, s59
    s_lshl_b32 s59, s3, 8
    s_add_u32 s58, s58, s59
    v_lshlrev_b32 v32, 7, v1
    v_min_u32 v32, 128, v32
    buffer_load_dword v33, v32, s[44:47], s58 offen sc1
    v_lshlrev_b32 v20, 16, v14
    v_and_b32 v21, 0xffff0000, v14
    v_lshlrev_b32 v22, 16, v15
    v_and_b32 v23, 0xffff0000, v15
    v_lshlrev_b32 v24, 16, v16
    v_and_b32 v25, 0xffff0000, v16
    v_lshlrev_b32 v26, 16, v17
    v_and_b32 v27, 0xffff0000, v17
    v_lshlrev_b32 v28, 16, v18
    v_and_b32 v29, 0xffff0000, v18
    v_add_f32 v8, v20, v21
    v_add_f32 v9, v22, v23
    v_add_f32 v10, v24, v25
    v_add_f32 v11, v26, v27
    v_add_f32 v14, v28, v29
    v_add_f32 v8, v8, v9
    v_add_f32 v10, v10, v11
    v_add_f32 v8, v8, v14
    v_add_f32 v8, v8, v10
    s_nop 1
    v_add_f32_dpp v8, v8, v8 row_ror:8 row_mask:0xf bank_mask:0xf
    s_nop 1
    v_add_f32_dpp v8, v8, v8 row_ror:4 row_mask:0xf bank_mask:0xf
    s_nop 1
    v_add_f32_dpp v8, v8, v8 row_ror:2 row_mask:0xf bank_mask:0xf
    s_nop 1
    v_add_f32_dpp v8, v8, v8 row_ror:1 row_mask:0xf bank_mask:0xf
    v_mov_b32 v9, v8
    s_nop 1
    v_permlane16_swap_b32 v8, v9
    v_add_f32 v8, v8, v9
    v_mov_b32 v9, v8
    s_nop 1
    v_permlane32_swap_b32 v8, v9
    v_add_f32 v8, v8, v9
    v_mul_f32 v8, 0x3ae38e39, v8
    v_cmp_gt_u32 vcc, 32, v1
    v_sub_f32 v40, v20, v8
    v_sub_f32 v41, v21, v8
    v_sub_f32 v42, v22, v8
    v_sub_f32 v43, v23, v8
    v_sub_f32 v44, v24, v8
    v_sub_f32 v45, v25, v8
    v_sub_f32 v46, v26, v8
    v_sub_f32 v47, v27, v8
    v_sub_f32 v48, v28, v8
    v_sub_f32 v49, v29, v8
    v_cndmask_b32 v48, 0, v48, vcc
    v_cndmask_b32 v49, 0, v49, vcc
    v_mul_f32 v10, v40, v40
    v_mul_f32 v11, v41, v41
    v_fmac_f32 v10, v42, v42
    v_fmac_f32 v11, v43, v43
    v_fmac_f32 v10, v44, v44
    v_fmac_f32 v11, v45, v45
    v_fmac_f32 v10, v46, v46
    v_fmac_f32 v11, v47, v47
    v_fmac_f32 v10, v48, v48
    v_fmac_f32 v11, v49, v49
    v_add_f32 v10, v10, v11
    s_nop 1
    v_add_f32_dpp v10, v10, v10 row_ror:8 row_mask:0xf bank_mask:0xf
    s_nop 1
    v_add_f32_dpp v10, v10, v10 row_ror:4 row_mask:0xf bank_mask:0xf
    s_nop 1
    v_add_f32_dpp v10, v10, v10 row_ror:2 row_mask:0xf bank_mask:0xf
    s_nop 1
    v_add_f32_dpp v10, v10, v10 row_ror:1 row_mask:0xf bank_mask:0xf
    v_mov_b32 v11, v10
    s_nop 1
    v_permlane16_swap_b32 v10, v11
    v_add_f32 v10, v10, v11
    v_mov_b32 v11, v10
    s_nop 1
    v_permlane32_swap_b32 v10, v11
    v_add_f32 v10, v10, v11
    v_mul_f32 v10, 0x3ae38e39, v10
    v_cvt_pk_bf16_f32 v8, v8, v8
    v_lshlrev_b32 v8, 16, v8
    v_cvt_pk_bf16_f32 v10, v10, v10
    v_lshlrev_b32 v10, 16, v10
    v_add_f32 v10, 0x3727c5ac, v10
    v_cvt_pk_bf16_f32 v10, v10, v10
    v_lshlrev_b32 v10, 16, v10
    v_sqrt_f32 v10, v10
    s_nop 0
    v_cvt_pk_bf16_f32 v10, v10, v10
    v_lshlrev_b32 v10, 16, v10
    v_rcp_f32 v10, v10
    v_sub_f32 v20, v20, v8
    v_sub_f32 v21, v21, v8
    v_sub_f32 v22, v22, v8
    v_sub_f32 v23, v23, v8
    v_sub_f32 v24, v24, v8
    v_sub_f32 v25, v25, v8
    v_sub_f32 v26, v26, v8
    v_sub_f32 v27, v27, v8
    v_sub_f32 v28, v28, v8
    v_sub_f32 v29, v29, v8
    v_cvt_pk_bf16_f32 v14, v20, v21
    v_cvt_pk_bf16_f32 v15, v22, v23
    v_cvt_pk_bf16_f32 v16, v24, v25
    v_cvt_pk_bf16_f32 v17, v26, v27
    v_cvt_pk_bf16_f32 v18, v28, v29
    v_lshlrev_b32 v20, 16, v14
    v_and_b32 v21, 0xffff0000, v14
    v_mul_f32 v20, v20, v10
    v_mul_f32 v21, v21, v10
    v_lshlrev_b32 v22, 16, v15
    v_and_b32 v23, 0xffff0000, v15
    v_mul_f32 v22, v22, v10
    v_mul_f32 v23, v23, v10
    v_lshlrev_b32 v24, 16, v16
    v_and_b32 v25, 0xffff0000, v16
    v_mul_f32 v24, v24, v10
    v_mul_f32 v25, v25, v10
    v_lshlrev_b32 v26, 16, v17
    v_and_b32 v27, 0xffff0000, v17
    v_mul_f32 v26, v26, v10
    v_mul_f32 v27, v27, v10
    v_lshlrev_b32 v28, 16, v18
    v_and_b32 v29, 0xffff0000, v18
    v_mul_f32 v28, v28, v10
    v_mul_f32 v29, v29, v10
    v_add_u32 v7, 162048, v7
    v_add_u32 v8, 161024, v6
    v_cvt_pk_bf16_f32 v14, v20, v21
    v_cvt_pk_bf16_f32 v15, v22, v23
    v_cvt_pk_bf16_f32 v16, v24, v25
    v_cvt_pk_bf16_f32 v17, v26, v27
    v_cvt_pk_bf16_f32 v18, v28, v29
    ds_write_b128 v8, v[14:17]
    ds_write_b32 v7, v18
    s_lshl_b32 s58, s100, 3
    s_add_u32 s58, s58, 161024
    v_lshl_add_u32 v9, v3, 3, s58
    s_waitcnt lgkmcnt(0)
    s_add_u32 s52, s52, 0x9e3779b1
    ds_read_b64 v[80:81], v9 offset:0
    ds_read_b64 v[82:83], v9 offset:32
    ds_read_b64 v[84:85], v9 offset:64
    ds_read_b64 v[86:87], v9 offset:96
    ds_read_b64 v[88:89], v9 offset:128
    v_and_b32 v8, 7, v4
    s_lshl_b32 s58, s3, 1
    v_xor_b32 v8, s58, v8
    v_lshl_add_u32 v8, v8, 5, v5
    v_lshl_add_u32 v36, v4, 8, v8
    v_xor_b32 v37, 32, v36
    v_add_u32 v38, 126976, v36
    v_add_u32 v39, 126976, v37
    v_mov_b32 v70, 0
    v_mov_b32 v71, s52
    s_lshl_b32 s58, s53, 3
    s_add_u32 s58, s58, s54
    s_lshl_b32 s58, s58, 2
    s_add_u32 s58, s58, s3
    s_lshl_b32 s58, s58, 8
    s_add_u32 s58, s58, 65536
    s_cmp_ge_u32 s2, 128
    s_cbranch_scc1 L_B
    s_mov_b32 m0, s31
    s_add_u32 s31, s31, 4096
    buffer_load_dwordx4 v12, s[36:39], s30 offen nt lds
    s_add_u32 s30, s30, 8192
    s_mov_b32 m0, s31
    s_add_u32 s31, s31, 4096
    buffer_load_dwordx4 v12, s[36:39], s30 offen nt lds
    s_add_u32 s30, s30, 8192
    s_mov_b32 m0, s31
    s_add_u32 s31, s31, 4096
    buffer_load_dwordx4 v12, s[36:39], s30 offen nt lds
    s_add_u32 s30, s30, 8192
    s_mov_b32 m0, s31
    s_add_u32 s31, s31, 4096
    buffer_load_dwordx4 v12, s[36:39], s30 offen nt lds
    s_add_u32 s30, s30, 8192
    s_waitcnt lgkmcnt(0) vmcnt(9)
    s_barrier
    ds_read_b64_tr_b16 v[100:101], v38 offset:0
    ds_read_b64_tr_b16 v[120:121], v39 offset:0
    ds_read_b64_tr_b16 v[102:103], v38 offset:4096
    ds_read_b64_tr_b16 v[122:123], v39 offset:4096
    ds_read_b64_tr_b16 v[104:105], v38 offset:8192
    ds_read_b64_tr_b16 v[124:125], v39 offset:8192
    ds_read_b64_tr_b16 v[106:107], v38 offset:12288
    ds_read_b64_tr_b16 v[126:127], v39 offset:12288
    s_waitcnt lgkmcnt(5)
    v_mfma_f32_16x16x32_bf16 v[72:75], v[80:83], v[100:103], 0
    s_waitcnt lgkmcnt(4)
    v_mfma_f32_16x16x32_bf16 v[76:79], v[80:83], v[120:123], 0
    s_waitcnt lgkmcnt(1)
    v_mfma_f32_16x16x32_bf16 v[72:75], v[84:87], v[104:107], v[72:75]
    s_waitcnt lgkmcnt(0)
    v_mfma_f32_16x16x32_bf16 v[76:79], v[84:87], v[124:127], v[76:79]
    s_mov_b64 exec, 0xffff
    s_nop 4
    v_mov_b32 v68, v72
    s_nop 0
    v_mov_b32 v69, v76
    s_add_u32 s61, s58, 4194304
    buffer_store_dwordx4 v[68:71], v6, s[44:47], s61 offen
    buffer_store_dwordx4 v[68:71], v6, s[44:47], s58 offen sc1
    s_mov_b64 exec, -1
    v_and_b32 v24, 7, v2
    v_lshlrev_b32 v24, 1, v24
    v_xor_b32 v24, v24, v3
    v_lshlrev_b32 v24, 4, v24
    v_lshl_add_u32 v24, v2, 8, v24
    s_lshl_b32 s58, s3, 13
    v_add_u32 v16, s58, v24
    v_xor_b32 v17, 64, v16
    v_xor_b32 v18, 128, v16
    v_xor_b32 v19, 192, v16
    v_lshlrev_b32 v8, 6, v3
    v_lshl_add_u32 v8, v2, 1, v8
    v_add_u32 v8, 159744, v8
    v_lshlrev_b32 v9, 4, v3
    v_add_u32 v9, 159744, v9
    s_lshl_b32 s58, s3, 2
    s_add_u32 s58, s58, 160000
    v_lshl_add_u32 v10, v2, 4, s58
    v_and_b32 v24, 7, v1
    v_lshlrev_b32 v24, 4, v24
    v_add_u32 v24, 160012, v24
    v_add_u32 v25, 160000, v6
    v_cmp_gt_u32 vcc, 16, v1
    v_add_u32 v26, 128, v24
    v_add_u32 v27, 4, v25
    v_cndmask_b32 v20, v24, v25, vcc
    v_cndmask_b32 v21, v26, v27, vcc
    v_add_u32 v27, 8, v25
    v_cndmask_b32 v22, v24, v27, vcc
    v_mov_b32 v15, s52
    s_lshl_b32 s58, s53, 13
    s_add_u32 s58, s58, 4259840
    s_add_u32 s59, s58, 4096
    v_mov_b32 v23, 0
    s_and_b32 s100, s2, 7
    s_lshl_b32 s100, s100, 2
    s_add_u32 s100, s100, s54
    s_lshl_b32 s100, s100, 7
    s_add_u32 s100, s100, 40960
    s_mov_b32 s32, s18
    s_mov_b32 s33, s19
    s_mov_b32 s34, 5308416
    s_mov_b32 s35, 0x20000
    s_mov_b32 s40, s20
    s_mov_b32 s41, s21
    s_mov_b32 s42, 5308416
    s_mov_b32 s43, 0x20000
    v_lshrrev_b32 v36, 3, v1
    v_mul_u32_u24 v37, 9216, v36
    v_and_b32 v36, 6, v36
    v_xor_b32 v36, v36, v1
    v_and_b32 v36, 7, v36
    v_lshl_add_u32 v37, v36, 4, v37
    s_and_b32 s26, s2, 7
    s_mul_i32 s26, s26, 9
    s_lshr_b32 s60, s2, 3
    s_add_u32 s26, s26, s60
    s_mul_i32 s30, s3, 73728
    s_lshl_b32 s60, s26, 7
    s_add_u32 s30, s30, s60
    s_mov_b32 s55, s30
    s_cmp_lg_u32 s3, 0
    s_cbranch_scc1 L_e0_3
    s_waitcnt vmcnt(2)
    buffer_load_dwordx4 v[72:75], v6, s[44:47], s58 offen offset:0 sc1
    buffer_load_dwordx4 v[76:79], v6, s[44:47], s58 offen offset:1024 sc1
    buffer_load_dwordx4 v[80:83], v6, s[44:47], s58 offen offset:2048 sc1
    buffer_load_dwordx4 v[84:87], v6, s[44:47], s58 offen offset:3072 sc1
    buffer_load_dwordx4 v[88:91], v6, s[44:47], s59 offen offset:0 sc1
    buffer_load_dwordx4 v[92:95], v6, s[44:47], s59 offen offset:1024 sc1
    buffer_load_dwordx4 v[96:99], v6, s[44:47], s59 offen offset:2048 sc1
    buffer_load_dwordx4 v[100:103], v6, s[44:47], s59 offen offset:3072 sc1
    s_waitcnt vmcnt(10)
    s_branch L_e0_3_j
L_e0_3:
    s_waitcnt vmcnt(2)
L_e0_3_j:
    s_waitcnt lgkmcnt(0)
    s_barrier
    ds_read_b128 v[128:131], v16 offset:0
    ds_read_b128 v[132:135], v17 offset:0
    ds_read_b128 v[136:139], v18 offset:0
    ds_read_b128 v[140:143], v19 offset:0
    ds_read_b128 v[144:147], v16 offset:4096
    ds_read_b128 v[148:151], v17 offset:4096
    ds_read_b128 v[152:155], v18 offset:4096
    ds_read_b128 v[156:159], v19 offset:4096
    s_cmp_lg_u32 s3, 0
    s_cbranch_scc1 L_noh0_2
    s_mov_b32 s56, 15
    s_mov_b32 s57, 0
    s_branch L_h0_poll_4_w
L_h0_poll_4:
    s_bitcmp1_b32 s56, 0
    s_cbranch_scc0 L_sk_6
    buffer_load_dwordx4 v[72:75], v6, s[44:47], s58 offen offset:0 sc1
    buffer_load_dwordx4 v[76:79], v6, s[44:47], s58 offen offset:1024 sc1
L_sk_6:
    s_bitcmp1_b32 s56, 1
    s_cbranch_scc0 L_sk_7
    buffer_load_dwordx4 v[80:83], v6, s[44:47], s58 offen offset:2048 sc1
    buffer_load_dwordx4 v[84:87], v6, s[44:47], s58 offen offset:3072 sc1
L_sk_7:
    s_bitcmp1_b32 s56, 2
    s_cbranch_scc0 L_sk_8
    buffer_load_dwordx4 v[88:91], v6, s[44:47], s59 offen offset:0 sc1
    buffer_load_dwordx4 v[92:95], v6, s[44:47], s59 offen offset:1024 sc1
L_sk_8:
    s_bitcmp1_b32 s56, 3
    s_cbranch_scc0 L_sk_9
    buffer_load_dwordx4 v[96:99], v6, s[44:47], s59 offen offset:2048 sc1
    buffer_load_dwordx4 v[100:103], v6, s[44:47], s59 offen offset:3072 sc1
L_sk_9:
L_h0_poll_4_w:
    s_waitcnt vmcnt(0)
    s_bitcmp1_b32 s56, 0
    s_cbranch_scc0 L_ck_10
    v_cmp_eq_u32 s[62:63], s52, v75
    v_cmp_eq_u32 vcc, s52, v79
    s_and_b64 s[62:63], s[62:63], vcc
    s_cmp_eq_u64 s[62:63], exec
    s_cselect_b32 s61, 1, 0
    s_andn2_b32 s56, s56, s61
L_ck_10:
    s_bitcmp1_b32 s56, 1
    s_cbranch_scc0 L_ck_11
    v_cmp_eq_u32 s[62:63], s52, v83
    v_cmp_eq_u32 vcc, s52, v87
    s_and_b64 s[62:63], s[62:63], vcc
    s_cmp_eq_u64 s[62:63], exec
    s_cselect_b32 s61, 2, 0
    s_andn2_b32 s56, s56, s61
L_ck_11:
    s_bitcmp1_b32 s56, 2
    s_cbranch_scc0 L_ck_12
    v_cmp_eq_u32 s[62:63], s52, v91
    v_cmp_eq_u32 vcc, s52, v95
    s_and_b64 s[62:63], s[62:63], vcc
    s_cmp_eq_u64 s[62:63], exec
    s_cselect_b32 s61, 4, 0
    s_andn2_b32 s56, s56, s61
L_ck_12:
    s_bitcmp1_b32 s56, 3
    s_cbranch_scc0 L_ck_13
    v_cmp_eq_u32 s[62:63], s52, v99
    v_cmp_eq_u32 vcc, s52, v103
    s_and_b64 s[62:63], s[62:63], vcc
    s_cmp_eq_u64 s[62:63], exec
    s_cselect_b32 s61, 8, 0
    s_andn2_b32 s56, s56, s61
L_ck_13:
    s_cmp_ge_u32 s57, 12
    s_cselect_b32 s61, 4194304, 0
    s_xor_b32 s58, s58, s61
    s_xor_b32 s59, s59, s61
    s_cmp_lg_u32 s56, 0
    s_cbranch_scc0 L_h0_done_5
    s_add_u32 s57, s57, 1
    s_cmp_lt_u32 s57, 1048576
    s_cbranch_scc1 L_h0_poll_4
L_h0_done_5:
    v_add_f32 v56, v72, v76
    v_add_f32 v58, v80, v84
    v_add_f32 v60, v88, v92
    v_add_f32 v62, v96, v100
    v_add_f32 v57, v73, v77
    v_add_f32 v59, v81, v85
    v_add_f32 v61, v89, v93
    v_add_f32 v63, v97, v101
    s_and_b32 s60, s53, 3
    s_cmp_lg_u32 s60, 1
    s_cbranch_scc1 L_nh_14
    s_cmp_lg_u32 s3, 0
    s_cbranch_scc1 L_hint_15
    s_mov_b64 exec, 1
    buffer_store_dword v15, v23, s[44:47], s100 offen sc1
    s_mov_b64 exec, -1
L_hint_15:
L_nh_14:
    v_add_f32 v56, v56, v58
    v_add_f32 v57, v57, v59
    v_add_f32 v60, v60, v62
    v_add_f32 v61, v61, v63
    v_add_f32 v56, v56, v60
    v_add_f32 v57, v57, v61
    v_cvt_pk_bf16_f32 v56, v56, v57
    ds_write_b16 v8, v56
    ds_write_b16_d16_hi v8, v56 offset:32
L_noh0_2:
    s_waitcnt lgkmcnt(0)
    s_barrier
    ds_read_b128 v[104:107], v9 offset:0
    ds_read_b128 v[108:111], v9 offset:64
    ds_read_b128 v[112:115], v9 offset:128
    ds_read_b128 v[116:119], v9 offset:192
    s_lshl_b32 s58, s53, 2
    s_add_u32 s58, s58, s54
    s_mul_i32 s58, s58, 384
    s_add_u32 s58, s58, 327680
    s_mov_b32 s59, 0x3e0293ee
    s_waitcnt lgkmcnt(3)
    v_mfma_f32_16x16x32_bf16 v[224:227], v[104:107], v[128:131], 0
    v_mfma_f32_16x16x32_bf16 v[228:231], v[104:107], v[144:147], 0
    s_waitcnt lgkmcnt(2)
    v_mfma_f32_16x16x32_bf16 v[224:227], v[108:111], v[132:135], v[224:227]
    v_mfma_f32_16x16x32_bf16 v[228:231], v[108:111], v[148:151], v[228:231]
    s_waitcnt lgkmcnt(1)
    v_mfma_f32_16x16x32_bf16 v[224:227], v[112:115], v[136:139], v[224:227]
    v_mfma_f32_16x16x32_bf16 v[228:231], v[112:115], v[152:155], v[228:231]
    s_waitcnt lgkmcnt(0)
    v_mfma_f32_16x16x32_bf16 v[224:227], v[116:119], v[140:143], v[224:227]
    v_mfma_f32_16x16x32_bf16 v[228:231], v[116:119], v[156:159], v[228:231]
    s_mov_b64 exec, 0xffff
    s_nop 5
    v_mul_f32 v224, s59, v224
    v_mul_f32 v228, s59, v228
    v_cvt_pk_bf16_f32 v224, v224, v228
    ds_write_b32 v10, v224
    s_mov_b64 exec, -1
    s_waitcnt lgkmcnt(0)
    s_barrier
    s_cmp_lg_u32 s3, 0
    s_cbranch_scc1 L_nopub_16
    s_mov_b64 exec, 0xffffff
    ds_read_b32 v12, v20
    ds_read_b32 v13, v21
    ds_read_b32 v14, v22
    s_waitcnt lgkmcnt(0)
    buffer_store_dwordx4 v[12:15], v6, s[44:47], s58 offen sc1
    s_mov_b64 exec, -1
L_nopub_16:
    s_waitcnt lgkmcnt(0)
    s_barrier
    s_cmp_ge_u32 s2, 72
    s_cbranch_scc1 L_E
    s_lshl_b32 s31, s3, 10
    s_add_u32 s31, s31, 0
    s_mov_b32 m0, s31
    s_add_u32 s31, s31, 4096
    buffer_load_dwordx4 v37, s[32:35], s30 offen nt lds
    s_add_u32 s30, s30, 294912
    s_mov_b32 m0, s31
    s_add_u32 s31, s31, 4096
    buffer_load_dwordx4 v37, s[32:35], s30 offen nt lds
    s_add_u32 s30, s30, 294912
    s_mov_b32 m0, s31
    s_add_u32 s31, s31, 4096
    buffer_load_dwordx4 v37, s[32:35], s30 offen nt lds
    s_add_u32 s30, s30, 294912
    s_mov_b32 m0, s31
    s_add_u32 s31, s31, 4096
    buffer_load_dwordx4 v37, s[32:35], s30 offen nt lds
    s_add_u32 s30, s30, 294912
    s_mov_b32 m0, s31
    s_add_u32 s31, s31, 4096
    buffer_load_dwordx4 v37, s[32:35], s30 offen nt lds
    s_add_u32 s30, s30, 294912
    s_mov_b32 m0, s31
    s_add_u32 s31, s31, 4096
    buffer_load_dwordx4 v37, s[32:35], s30 offen nt lds
    s_add_u32 s30, s30, 294912
    s_lshl_b32 s31, s3, 10
    s_add_u32 s31, s31, 24576
    s_mov_b32 m0, s31
    s_add_u32 s31, s31, 4096
    buffer_load_dwordx4 v37, s[40:43], s55 offen nt lds
    s_add_u32 s55, s55, 294912
    s_mov_b32 m0, s31
    s_add_u32 s31, s31, 4096
    buffer_load_dwordx4 v37, s[40:43], s55 offen nt lds
    s_add_u32 s55, s55, 294912
    s_mov_b32 m0, s31
    s_add_u32 s31, s31, 4096
    buffer_load_dwordx4 v37, s[40:43], s55 offen nt lds
    s_add_u32 s55, s55, 294912
    s_mov_b32 m0, s31
    s_add_u32 s31, s31, 4096
    buffer_load_dwordx4 v37, s[40:43], s55 offen nt lds
    s_add_u32 s55, s55, 294912
    s_mov_b32 m0, s31
    s_add_u32 s31, s31, 4096
    buffer_load_dwordx4 v37, s[40:43], s55 offen nt lds
    s_add_u32 s55, s55, 294912
    s_mov_b32 m0, s31
    s_add_u32 s31, s31, 4096
    buffer_load_dwordx4 v37, s[40:43], s55 offen nt lds
    s_add_u32 s55, s55, 294912
    s_mov_b32 s36, s22
    s_mov_b32 s37, s23
    s_mov_b32 s38, 5308416
    s_mov_b32 s39, 0x20000
    v_mul_u32_u24 v8, 1056, v4
    s_lshl_b32 s59, s3, 8
    v_add3_u32 v8, v8, s59, v5
    v_bfe_u32 v24, v4, 1, 2
    v_xor_b32 v9, s3, v24
    v_lshl_add_u32 v9, v9, 5, v5
    v_lshl_add_u32 v9, v4, 7, v9
    v_lshrrev_b32 v24, 3, v1
    v_mul_u32_u24 v10, 1152, v24
    v_and_b32 v24, 6, v24
    v_xor_b32 v24, v24, v1
    v_and_b32 v24, 7, v24
    v_lshl_add_u32 v10, v24, 4, v10
    v_add_u32 v10, 1024, v10
    v_lshlrev_b32 v24, 3, v3
    v_add_u32 v24, 161024, v24
    ds_read_b64 a[0:1], v24 offset:0
    ds_read_b64 a[2:3], v24 offset:32
    ds_read_b64 a[4:5], v24 offset:64
    ds_read_b64 a[6:7], v24 offset:96
    ds_read_b64 a[8:9], v24 offset:128
    ds_read_b64 a[10:11], v24 offset:160
    ds_read_b64 a[12:13], v24 offset:192
    ds_read_b64 a[14:15], v24 offset:224
    ds_read_b64 a[16:17], v24 offset:256
    ds_read_b64 a[18:19], v24 offset:288
    ds_read_b64 a[20:21], v24 offset:320
    ds_read_b64 a[22:23], v24 offset:352
    ds_read_b64 a[24:25], v24 offset:384
    ds_read_b64 a[26:27], v24 offset:416
    ds_read_b64 a[28:29], v24 offset:448
    ds_read_b64 a[30:31], v24 offset:480
    ds_read_b64 a[32:33], v24 offset:512
    ds_read_b64 a[34:35], v24 offset:544
    ds_read_b64 a[36:37], v24 offset:576
    ds_read_b64 a[38:39], v24 offset:608
    ds_read_b64 a[40:41], v24 offset:640
    ds_read_b64 a[42:43], v24 offset:672
    ds_read_b64 a[44:45], v24 offset:704
    ds_read_b64 a[46:47], v24 offset:736
    ds_read_b64 a[48:49], v24 offset:768
    ds_read_b64 a[50:51], v24 offset:800
    ds_read_b64 a[52:53], v24 offset:832
    ds_read_b64 a[54:55], v24 offset:864
    ds_read_b64 a[56:57], v24 offset:896
    ds_read_b64 a[58:59], v24 offset:928
    ds_read_b64 a[60:61], v24 offset:960
    ds_read_b64 a[62:63], v24 offset:992
    ds_read_b64 a[64:65], v24 offset:1024
    ds_read_b64 a[66:67], v24 offset:1056
    ds_read_b64 a[68:69], v24 offset:1088
    ds_read_b64 a[70:71], v24 offset:1120
    s_lshl_b32 s31, s3, 10
    s_add_u32 s31, s31, 49152
    s_mov_b32 m0, s31
    s_add_u32 s31, s31, 4096
    buffer_load_dwordx4 v37, s[32:35], s30 offen nt lds
    s_add_u32 s30, s30, 294912
    s_mov_b32 m0, s31
    s_add_u32 s31, s31, 4096
    buffer_load_dwordx4 v37, s[32:35], s30 offen nt lds
    s_add_u32 s30, s30, 294912
    s_mov_b32 m0, s31
    s_add_u32 s31, s31, 4096
    buffer_load_dwordx4 v37, s[32:35], s30 offen nt lds
    s_add_u32 s30, s30, 294912
    s_mov_b32 m0, s31
    s_add_u32 s31, s31, 4096
    buffer_load_dwordx4 v37, s[32:35], s30 offen nt lds
    s_add_u32 s30, s30, 294912
    s_mov_b32 m0, s31
    s_add_u32 s31, s31, 4096
    buffer_load_dwordx4 v37, s[32:35], s30 offen nt lds
    s_add_u32 s30, s30, 294912
    s_mov_b32 m0, s31
    s_add_u32 s31, s31, 4096
    buffer_load_dwordx4 v37, s[32:35], s30 offen nt lds
    s_add_u32 s30, s30, 294912
    s_lshl_b32 s31, s3, 10
    s_add_u32 s31, s31, 73728
    s_mov_b32 m0, s31
    s_add_u32 s31, s31, 4096
    buffer_load_dwordx4 v37, s[40:43], s55 offen nt lds
    s_add_u32 s55, s55, 294912
    s_mov_b32 m0, s31
    s_add_u32 s31, s31, 4096
    buffer_load_dwordx4 v37, s[40:43], s55 offen nt lds
    s_add_u32 s55, s55, 294912
    s_mov_b32 m0, s31
    s_add_u32 s31, s31, 4096
    buffer_load_dwordx4 v37, s[40:43], s55 offen nt lds
    s_add_u32 s55, s55, 294912
    s_mov_b32 m0, s31
    s_add_u32 s31, s31, 4096
    buffer_load_dwordx4 v37, s[40:43], s55 offen nt lds
    s_add_u32 s55, s55, 294912
    s_mov_b32 m0, s31
    s_add_u32 s31, s31, 4096
    buffer_load_dwordx4 v37, s[40:43], s55 offen nt lds
    s_add_u32 s55, s55, 294912
    s_mov_b32 m0, s31
    s_add_u32 s31, s31, 4096
    buffer_load_dwordx4 v37, s[40:43], s55 offen nt lds
    s_add_u32 s55, s55, 294912
    v_add_u32 v12, 49152, v9
    v_add_u32 v13, 98304, v9
    v_add_u32 v14, 49152, v8
    s_lshr_b32 s58, s3, 1
    s_lshl_b32 s58, s58, 6
    s_and_b32 s59, s3, 1
    s_lshl_b32 s59, s59, 3
    s_add_u32 s58, s58, s59
    s_add_u32 s58, s58, 160256
    v_lshrrev_b32 v24, 2, v2
    v_lshl_add_u32 v15, v24, 4, s58
    v_and_b32 v24, 3, v2
    v_lshl_add_u32 v15, v24, 1, v15
    v_lshlrev_b32 v16, 4, v3
    v_add_u32 v16, 160256, v16
    v_mov_b32 v35, s52
    s_mul_i32 s100, s2, 64
    s_add_u32 s100, s100, 5244928
    s_mul_i32 s58, s3, 3
    v_add_u32 v17, s58, v3
    v_lshrrev_b32 v24, 2, v2
    v_lshl_add_u32 v17, v17, 2, v24
    v_mul_u32_u24 v17, 6656, v17
    v_lshl_add_u32 v17, v5, 1, v17
    v_cmp_eq_u32 s[96:97], 1, v3
    v_cmp_eq_u32 s[98:99], 2, v3
    s_waitcnt lgkmcnt(0) vmcnt(12)
    s_barrier
    s_lshl_b32 s31, s3, 10
    s_add_u32 s31, s31, 98304
    s_mov_b32 m0, s31
    s_add_u32 s31, s31, 4096
    buffer_load_dwordx4 v37, s[32:35], s30 offen nt lds
    s_add_u32 s30, s30, 294912
    s_mov_b32 m0, s31
    s_add_u32 s31, s31, 4096
    buffer_load_dwordx4 v37, s[32:35], s30 offen nt lds
    s_add_u32 s30, s30, 294912
    s_mov_b32 m0, s31
    s_add_u32 s31, s31, 4096
    buffer_load_dwordx4 v37, s[32:35], s30 offen nt lds
    s_add_u32 s30, s30, 294912
    s_mov_b32 m0, s31
    s_add_u32 s31, s31, 4096
    buffer_load_dwordx4 v37, s[32:35], s30 offen nt lds
    ds_read_b64_tr_b16 v[128:129], v9 offset:0
    ds_read_b64_tr_b16 v[130:131], v9 offset:2048
    ds_read_b64_tr_b16 v[132:133], v9 offset:24576
    ds_read_b64_tr_b16 v[134:135], v9 offset:26624
    ds_read_b64_tr_b16 v[136:137], v9 offset:4096
    ds_read_b64_tr_b16 v[138:139], v9 offset:6144
    ds_read_b64_tr_b16 v[140:141], v9 offset:28672
    ds_read_b64_tr_b16 v[142:143], v9 offset:30720
    ds_read_b64_tr_b16 v[144:145], v9 offset:8192
    ds_read_b64_tr_b16 v[146:147], v9 offset:10240
    ds_read_b64_tr_b16 v[148:149], v9 offset:32768
    ds_read_b64_tr_b16 v[150:151], v9 offset:34816
    s_waitcnt lgkmcnt(10)
    v_mfma_f32_16x16x32_bf16 v[40:43], a[0:3], v[128:131], 0
    ds_read_b64_tr_b16 v[152:153], v9 offset:12288
    ds_read_b64_tr_b16 v[154:155], v9 offset:14336
    s_add_u32 s30, s30, 294912
    s_mov_b32 m0, s31
    s_add_u32 s31, s31, 4096
    buffer_load_dwordx4 v37, s[32:35], s30 offen nt lds
    s_waitcnt lgkmcnt(10)
    v_mfma_f32_16x16x32_bf16 v[44:47], a[0:3], v[132:135], 0
    ds_read_b64_tr_b16 v[156:157], v9 offset:36864
    ds_read_b64_tr_b16 v[158:159], v9 offset:38912
    s_add_u32 s30, s30, 294912
    s_mov_b32 m0, s31
    s_add_u32 s31, s31, 4096
    buffer_load_dwordx4 v37, s[32:35], s30 offen nt lds
    s_waitcnt lgkmcnt(10)
    v_mfma_f32_16x16x32_bf16 v[40:43], a[4:7], v[136:139], v[40:43]
    ds_read_b64_tr_b16 v[128:129], v9 offset:16384
    ds_read_b64_tr_b16 v[130:131], v9 offset:18432
    s_add_u32 s30, s30, 294912
    s_lshl_b32 s31, s3, 10
    s_add_u32 s31, s31, 122880
    s_mov_b32 m0, s31
    s_add_u32 s31, s31, 4096
    buffer_load_dwordx4 v37, s[40:43], s55 offen nt lds
    s_waitcnt lgkmcnt(10)
    v_mfma_f32_16x16x32_bf16 v[44:47], a[4:7], v[140:143], v[44:47]
    ds_read_b64_tr_b16 v[132:133], v9 offset:40960
    ds_read_b64_tr_b16 v[134:135], v9 offset:43008
    s_add_u32 s55, s55, 294912
    s_mov_b32 m0, s31
    s_add_u32 s31, s31, 4096
    buffer_load_dwordx4 v37, s[40:43], s55 offen nt lds
    s_waitcnt lgkmcnt(10)
    v_mfma_f32_16x16x32_bf16 v[40:43], a[8:11], v[144:147], v[40:43]
    ds_read_b64_tr_b16 v[136:137], v9 offset:20480
    ds_read_b64_tr_b16 v[138:139], v9 offset:22528
    s_add_u32 s55, s55, 294912
    s_mov_b32 m0, s31
    s_add_u32 s31, s31, 4096
    buffer_load_dwordx4 v37, s[40:43], s55 offen nt lds
    s_waitcnt lgkmcnt(10)
    v_mfma_f32_16x16x32_bf16 v[44:47], a[8:11], v[148:151], v[44:47]
    ds_read_b64_tr_b16 v[140:141], v9 offset:45056
    ds_read_b64_tr_b16 v[142:143], v9 offset:47104
    s_add_u32 s55, s55, 294912
    s_mov_b32 m0, s31
    s_add_u32 s31, s31, 4096
    buffer_load_dwordx4 v37, s[40:43], s55 offen nt lds
    s_waitcnt lgkmcnt(10)
    v_mfma_f32_16x16x32_bf16 v[40:43], a[12:15], v[152:155], v[40:43]
    s_add_u32 s55, s55, 294912
    s_mov_b32 m0, s31
    s_add_u32 s31, s31, 4096
    buffer_load_dwordx4 v37, s[40:43], s55 offen nt lds
    s_waitcnt lgkmcnt(8)
    v_mfma_f32_16x16x32_bf16 v[44:47], a[12:15], v[156:159], v[44:47]
    s_add_u32 s55, s55, 294912
    s_mov_b32 m0, s31
    s_add_u32 s31, s31, 4096
    buffer_load_dwordx4 v37, s[40:43], s55 offen nt lds
    s_add_u32 s55, s55, 294912
    s_waitcnt lgkmcnt(6)
    v_mfma_f32_16x16x32_bf16 v[40:43], a[16:19], v[128:131], v[40:43]
    s_waitcnt lgkmcnt(4)
    v_mfma_f32_16x16x32_bf16 v[44:47], a[16:19], v[132:135], v[44:47]
    s_waitcnt lgkmcnt(2)
    v_mfma_f32_16x16x32_bf16 v[40:43], a[20:23], v[136:139], v[40:43]
    s_waitcnt lgkmcnt(0)
    v_mfma_f32_16x16x32_bf16 v[44:47], a[20:23], v[140:143], v[44:47]
    s_waitcnt lgkmcnt(0) vmcnt(12)
    s_barrier
    s_lshl_b32 s30, s26, 3
    s_add_u32 s30, s30, s3
    s_add_u32 s30, s30, 0
    s_mul_i32 s30, s30, 9216
    s_mov_b32 s55, s30
    s_mul_i32 s31, s3, 8448
    s_add_u32 s31, s31, 0
    s_mov_b32 m0, s31
    s_add_u32 s31, s31, 1056
    buffer_load_dwordx4 v6, s[36:39], s30 offen nt lds
    s_add_u32 s30, s30, 1152
    s_mov_b32 m0, s31
    s_add_u32 s31, s31, 1056
    buffer_load_dwordx4 v6, s[36:39], s30 offen nt lds
    s_add_u32 s30, s30, 1152
    s_mov_b32 m0, s31
    s_add_u32 s31, s31, 1056
    buffer_load_dwordx4 v6, s[36:39], s30 offen nt lds
    s_add_u32 s30, s30, 1152
    s_mov_b32 m0, s31
    s_add_u32 s31, s31, 1056
    buffer_load_dwordx4 v6, s[36:39], s30 offen nt lds
    ds_read_b64_tr_b16 v[128:129], v12 offset:0
    ds_read_b64_tr_b16 v[130:131], v12 offset:2048
    ds_read_b64_tr_b16 v[132:133], v12 offset:24576
    ds_read_b64_tr_b16 v[134:135], v12 offset:26624
    ds_read_b64_tr_b16 v[136:137], v12 offset:4096
    ds_read_b64_tr_b16 v[138:139], v12 offset:6144
    ds_read_b64_tr_b16 v[140:141], v12 offset:28672
    ds_read_b64_tr_b16 v[142:143], v12 offset:30720
    ds_read_b64_tr_b16 v[144:145], v12 offset:8192
    ds_read_b64_tr_b16 v[146:147], v12 offset:10240
    ds_read_b64_tr_b16 v[148:149], v12 offset:32768
    ds_read_b64_tr_b16 v[150:151], v12 offset:34816
    s_waitcnt lgkmcnt(10)
    v_mfma_f32_16x16x32_bf16 v[40:43], a[24:27], v[128:131], v[40:43]
    ds_read_b64_tr_b16 v[152:153], v12 offset:12288
    ds_read_b64_tr_b16 v[154:155], v12 offset:14336
    s_add_u32 s30, s30, 1152
    s_mov_b32 m0, s31
    s_add_u32 s31, s31, 1056
    buffer_load_dwordx4 v6, s[36:39], s30 offen nt lds
    s_waitcnt lgkmcnt(10)
    v_mfma_f32_16x16x32_bf16 v[44:47], a[24:27], v[132:135], v[44:47]
    ds_read_b64_tr_b16 v[156:157], v12 offset:36864
    ds_read_b64_tr_b16 v[158:159], v12 offset:38912
    s_add_u32 s30, s30, 1152
    s_mov_b32 m0, s31
    s_add_u32 s31, s31, 1056
    buffer_load_dwordx4 v6, s[36:39], s30 offen nt lds
    s_waitcnt lgkmcnt(10)
    v_mfma_f32_16x16x32_bf16 v[40:43], a[28:31], v[136:139], v[40:43]
    ds_read_b64_tr_b16 v[128:129], v12 offset:16384
    ds_read_b64_tr_b16 v[130:131], v12 offset:18432
    s_add_u32 s30, s30, 1152
    s_mov_b32 m0, s31
    s_add_u32 s31, s31, 1056
    buffer_load_dwordx4 v6, s[36:39], s30 offen nt lds
    s_waitcnt lgkmcnt(10)
    v_mfma_f32_16x16x32_bf16 v[44:47], a[28:31], v[140:143], v[44:47]
    ds_read_b64_tr_b16 v[132:133], v12 offset:40960
    ds_read_b64_tr_b16 v[134:135], v12 offset:43008
    s_add_u32 s30, s30, 1152
    s_mov_b32 m0, s31
    s_add_u32 s31, s31, 1056
    buffer_load_dwordx4 v6, s[36:39], s30 offen nt lds
    s_waitcnt lgkmcnt(10)
    v_mfma_f32_16x16x32_bf16 v[40:43], a[32:35], v[144:147], v[40:43]
    ds_read_b64_tr_b16 v[136:137], v12 offset:20480
    ds_read_b64_tr_b16 v[138:139], v12 offset:22528
    s_add_u32 s30, s30, 1152
    s_lshl_b32 s31, s3, 10
    s_add_u32 s31, s31, 33792
    s_mov_b32 m0, s31
    s_add_u32 s31, s31, 0
    buffer_load_dwordx4 v10, s[36:39], s55 offen nt lds
    s_add_u32 s55, s55, 0
    s_waitcnt lgkmcnt(10)
    v_mfma_f32_16x16x32_bf16 v[44:47], a[32:35], v[148:151], v[44:47]
    ds_read_b64_tr_b16 v[140:141], v12 offset:45056
    ds_read_b64_tr_b16 v[142:143], v12 offset:47104
    s_waitcnt lgkmcnt(10)
    v_mfma_f32_16x16x32_bf16 v[40:43], a[36:39], v[152:155], v[40:43]
    s_waitcnt lgkmcnt(8)
    v_mfma_f32_16x16x32_bf16 v[44:47], a[36:39], v[156:159], v[44:47]
    s_waitcnt lgkmcnt(6)
    v_mfma_f32_16x16x32_bf16 v[40:43], a[40:43], v[128:131], v[40:43]
    s_waitcnt lgkmcnt(4)
    v_mfma_f32_16x16x32_bf16 v[44:47], a[40:43], v[132:135], v[44:47]
    s_waitcnt lgkmcnt(2)
    v_mfma_f32_16x16x32_bf16 v[40:43], a[44:47], v[136:139], v[40:43]
    s_waitcnt lgkmcnt(0)
    v_mfma_f32_16x16x32_bf16 v[44:47], a[44:47], v[140:143], v[44:47]
    s_waitcnt lgkmcnt(0) vmcnt(9)
    s_barrier
    s_lshl_b32 s30, s26, 3
    s_add_u32 s30, s30, s3
    s_add_u32 s30, s30, 4
    s_mul_i32 s30, s30, 9216
    s_mov_b32 s55, s30
    s_mul_i32 s31, s3, 8448
    s_add_u32 s31, s31, 49152
    s_mov_b32 m0, s31
    s_add_u32 s31, s31, 1056
    buffer_load_dwordx4 v6, s[36:39], s30 offen nt lds
    s_add_u32 s30, s30, 1152
    s_mov_b32 m0, s31
    s_add_u32 s31, s31, 1056
    buffer_load_dwordx4 v6, s[36:39], s30 offen nt lds
    s_add_u32 s30, s30, 1152
    s_mov_b32 m0, s31
    s_add_u32 s31, s31, 1056
    buffer_load_dwordx4 v6, s[36:39], s30 offen nt lds
    s_add_u32 s30, s30, 1152
    s_mov_b32 m0, s31
    s_add_u32 s31, s31, 1056
    buffer_load_dwordx4 v6, s[36:39], s30 offen nt lds
    ds_read_b64_tr_b16 v[128:129], v13 offset:0
    ds_read_b64_tr_b16 v[130:131], v13 offset:2048
    ds_read_b64_tr_b16 v[132:133], v13 offset:24576
    ds_read_b64_tr_b16 v[134:135], v13 offset:26624
    ds_read_b64_tr_b16 v[136:137], v13 offset:4096
    ds_read_b64_tr_b16 v[138:139], v13 offset:6144
    ds_read_b64_tr_b16 v[140:141], v13 offset:28672
    ds_read_b64_tr_b16 v[142:143], v13 offset:30720
    ds_read_b64_tr_b16 v[144:145], v13 offset:8192
    ds_read_b64_tr_b16 v[146:147], v13 offset:10240
    ds_read_b64_tr_b16 v[148:149], v13 offset:32768
    ds_read_b64_tr_b16 v[150:151], v13 offset:34816
    s_waitcnt lgkmcnt(10)
    v_mfma_f32_16x16x32_bf16 v[40:43], a[48:51], v[128:131], v[40:43]
    ds_read_b64_tr_b16 v[152:153], v13 offset:12288
    ds_read_b64_tr_b16 v[154:155], v13 offset:14336
    s_add_u32 s30, s30, 1152
    s_mov_b32 m0, s31
    s_add_u32 s31, s31, 1056
    buffer_load_dwordx4 v6, s[36:39], s30 offen nt lds
    s_waitcnt lgkmcnt(10)
    v_mfma_f32_16x16x32_bf16 v[44:47], a[48:51], v[132:135], v[44:47]
    ds_read_b64_tr_b16 v[156:157], v13 offset:36864
    ds_read_b64_tr_b16 v[158:159], v13 offset:38912
    s_add_u32 s30, s30, 1152
    s_mov_b32 m0, s31
    s_add_u32 s31, s31, 1056
    buffer_load_dwordx4 v6, s[36:39], s30 offen nt lds
    s_waitcnt lgkmcnt(10)
    v_mfma_f32_16x16x32_bf16 v[40:43], a[52:55], v[136:139], v[40:43]
    ds_read_b64_tr_b16 v[128:129], v13 offset:16384
    ds_read_b64_tr_b16 v[130:131], v13 offset:18432
    s_add_u32 s30, s30, 1152
    s_mov_b32 m0, s31
    s_add_u32 s31, s31, 1056
    buffer_load_dwordx4 v6, s[36:39], s30 offen nt lds
    s_waitcnt lgkmcnt(10)
    v_mfma_f32_16x16x32_bf16 v[44:47], a[52:55], v[140:143], v[44:47]
    ds_read_b64_tr_b16 v[132:133], v13 offset:40960
    ds_read_b64_tr_b16 v[134:135], v13 offset:43008
    s_add_u32 s30, s30, 1152
    s_mov_b32 m0, s31
    s_add_u32 s31, s31, 1056
    buffer_load_dwordx4 v6, s[36:39], s30 offen nt lds
    s_waitcnt lgkmcnt(10)
    v_mfma_f32_16x16x32_bf16 v[40:43], a[56:59], v[144:147], v[40:43]
    ds_read_b64_tr_b16 v[136:137], v13 offset:20480
    ds_read_b64_tr_b16 v[138:139], v13 offset:22528
    s_add_u32 s30, s30, 1152
    s_lshl_b32 s31, s3, 10
    s_add_u32 s31, s31, 82944
    s_mov_b32 m0, s31
    s_add_u32 s31, s31, 0
    buffer_load_dwordx4 v10, s[36:39], s55 offen nt lds
    s_add_u32 s55, s55, 0
    s_waitcnt lgkmcnt(10)
    v_mfma_f32_16x16x32_bf16 v[44:47], a[56:59], v[148:151], v[44:47]
    ds_read_b64_tr_b16 v[140:141], v13 offset:45056
    ds_read_b64_tr_b16 v[142:143], v13 offset:47104
    s_waitcnt lgkmcnt(10)
    v_mfma_f32_16x16x32_bf16 v[40:43], a[60:63], v[152:155], v[40:43]
    s_waitcnt lgkmcnt(8)
    v_mfma_f32_16x16x32_bf16 v[44:47], a[60:63], v[156:159], v[44:47]
    s_waitcnt lgkmcnt(6)
    v_mfma_f32_16x16x32_bf16 v[40:43], a[64:67], v[128:131], v[40:43]
    s_waitcnt lgkmcnt(4)
    v_mfma_f32_16x16x32_bf16 v[44:47], a[64:67], v[132:135], v[44:47]
    s_waitcnt lgkmcnt(2)
    v_mfma_f32_16x16x32_bf16 v[40:43], a[68:71], v[136:139], v[40:43]
    s_waitcnt lgkmcnt(0)
    v_mfma_f32_16x16x32_bf16 v[44:47], a[68:71], v[140:143], v[44:47]
    s_mov_b64 exec, 0xffff
    s_nop 6
    v_cvt_pk_bf16_f32 v40, v40, v44
    v_lshlrev_b32 v41, 16, v40
    v_and_b32 v40, 0xffff0000, v40
    v_mul_f32 v41, 0xbfb8aa3b, v41
    v_exp_f32 v41, v41
    s_nop 0
    v_add_f32 v41, 1.0, v41
    v_rcp_f32 v41, v41
    s_nop 0
    v_cvt_pk_bf16_f32 v41, v41, v41
    v_lshlrev_b32 v41, 16, v41
    v_mul_f32 v40, v40, v41
    v_cvt_pk_bf16_f32 v40, v40, v40
    ds_write_b16 v15, v40
    s_mov_b64 exec, -1
    s_waitcnt lgkmcnt(0) vmcnt(9)
    s_barrier
    ds_read_b128 v[24:27], v16
    ds_read_b128 v[28:31], v16 offset:64
    ds_read_b64_tr_b16 v[128:129], v8 offset:0
    ds_read_b64_tr_b16 v[130:131], v8 offset:16896
    ds_read_b64_tr_b16 v[132:133], v8 offset:32
    ds_read_b64_tr_b16 v[134:135], v8 offset:16928
    ds_read_b64_tr_b16 v[136:137], v8 offset:64
    ds_read_b64_tr_b16 v[138:139], v8 offset:16960
    ds_read_b64_tr_b16 v[140:141], v8 offset:96
    ds_read_b64_tr_b16 v[142:143], v8 offset:16992
    ds_read_b64_tr_b16 v[144:145], v8 offset:128
    ds_read_b64_tr_b16 v[146:147], v8 offset:17024
    ds_read_b64_tr_b16 v[148:149], v8 offset:160
    ds_read_b64_tr_b16 v[150:151], v8 offset:17056
    s_waitcnt lgkmcnt(10)
    v_mfma_f32_16x16x32_bf16 v[40:43], v[24:27], v[128:131], 0
    ds_read_b64_tr_b16 v[152:153], v8 offset:192
    ds_read_b64_tr_b16 v[154:155], v8 offset:17088
    s_waitcnt lgkmcnt(10)
    v_mfma_f32_16x16x32_bf16 v[44:47], v[24:27], v[132:135], 0
    ds_read_b64_tr_b16 v[156:157], v8 offset:224
    ds_read_b64_tr_b16 v[158:159], v8 offset:17120
    s_waitcnt lgkmcnt(10)
    v_mfma_f32_16x16x32_bf16 v[48:51], v[24:27], v[136:139], 0
    ds_read_b64_tr_b16 v[160:161], v9 offset:33792
    ds_read_b64_tr_b16 v[162:163], v9 offset:35840
    s_waitcnt lgkmcnt(10)
    v_mfma_f32_16x16x32_bf16 v[52:55], v[24:27], v[140:143], 0
    s_waitcnt lgkmcnt(8)
    v_mfma_f32_16x16x32_bf16 v[56:59], v[24:27], v[144:147], 0
    s_waitcnt lgkmcnt(6)
    v_mfma_f32_16x16x32_bf16 v[60:63], v[24:27], v[148:151], 0
    s_waitcnt lgkmcnt(4)
    v_mfma_f32_16x16x32_bf16 v[64:67], v[24:27], v[152:155], 0
    s_waitcnt lgkmcnt(2)
    v_mfma_f32_16x16x32_bf16 v[68:71], v[24:27], v[156:159], 0
    s_waitcnt lgkmcnt(0)
    v_mfma_f32_16x16x32_bf16 v[72:75], v[24:27], v[160:163], 0
    s_waitcnt lgkmcnt(0) vmcnt(0)
    s_barrier
    ds_read_b64_tr_b16 v[128:129], v14 offset:0
    ds_read_b64_tr_b16 v[130:131], v14 offset:16896
    ds_read_b64_tr_b16 v[132:133], v14 offset:32
    ds_read_b64_tr_b16 v[134:135], v14 offset:16928
    ds_read_b64_tr_b16 v[136:137], v14 offset:64
    ds_read_b64_tr_b16 v[138:139], v14 offset:16960
    ds_read_b64_tr_b16 v[140:141], v14 offset:96
    ds_read_b64_tr_b16 v[142:143], v14 offset:16992
    ds_read_b64_tr_b16 v[144:145], v14 offset:128
    ds_read_b64_tr_b16 v[146:147], v14 offset:17024
    ds_read_b64_tr_b16 v[148:149], v14 offset:160
    ds_read_b64_tr_b16 v[150:151], v14 offset:17056
    s_waitcnt lgkmcnt(10)
    v_mfma_f32_16x16x32_bf16 v[40:43], v[28:31], v[128:131], v[40:43]
    ds_read_b64_tr_b16 v[152:153], v14 offset:192
    ds_read_b64_tr_b16 v[154:155], v14 offset:17088
    s_waitcnt lgkmcnt(10)
    v_mfma_f32_16x16x32_bf16 v[44:47], v[28:31], v[132:135], v[44:47]
    ds_read_b64_tr_b16 v[156:157], v14 offset:224
    ds_read_b64_tr_b16 v[158:159], v14 offset:17120
    s_waitcnt lgkmcnt(10)
    v_mfma_f32_16x16x32_bf16 v[48:51], v[28:31], v[136:139], v[48:51]
    ds_read_b64_tr_b16 v[160:161], v12 offset:33792
    ds_read_b64_tr_b16 v[162:163], v12 offset:35840
    s_waitcnt lgkmcnt(10)
    v_mfma_f32_16x16x32_bf16 v[52:55], v[28:31], v[140:143], v[52:55]
    s_waitcnt lgkmcnt(8)
    v_mfma_f32_16x16x32_bf16 v[56:59], v[28:31], v[144:147], v[56:59]
    s_waitcnt lgkmcnt(6)
    v_mfma_f32_16x16x32_bf16 v[60:63], v[28:31], v[148:151], v[60:63]
    s_waitcnt lgkmcnt(4)
    v_mfma_f32_16x16x32_bf16 v[64:67], v[28:31], v[152:155], v[64:67]
    s_waitcnt lgkmcnt(2)
    v_mfma_f32_16x16x32_bf16 v[68:71], v[28:31], v[156:159], v[68:71]
    s_waitcnt lgkmcnt(0)
    v_mfma_f32_16x16x32_bf16 v[72:75], v[28:31], v[160:163], v[72:75]
    v_cndmask_b32 v32, v40, v52, s[96:97]
    v_cndmask_b32 v33, v44, v56, s[96:97]
    v_cndmask_b32 v34, v48, v60, s[96:97]
    s_nop 0
    v_cndmask_b32 v32, v32, v64, s[98:99]
    s_nop 0
    v_cndmask_b32 v33, v33, v68, s[98:99]
    s_nop 0
    v_cndmask_b32 v34, v34, v72, s[98:99]
    s_mov_b32 exec_hi, 0xffff
    buffer_store_dwordx4 v[32:35], v17, s[44:47], s100 offen sc1
    s_mov_b32 exec_hi, -1
    s_branch L_exit
L_E:
    s_cmp_ge_u32 s2, 104
    s_cbranch_scc1 L_H
    s_lshl2_add_u32 s58, s53, s3
    s_lshl_b32 s58, s58, 10
    s_add_u32 s58, s58, 4980736
    v_lshlrev_b32 v24, 7, v1
    v_min_u32 v24, 896, v24
    buffer_load_dword v25, v24, s[44:47], s58 offen sc1
    s_mov_b32 s40, s14
    s_mov_b32 s41, s15
    s_mov_b32 s42, 4718592
    s_mov_b32 s43, 0x20000
    v_mul_u32_u24 v8, 1056, v4
    s_lshl_b32 s59, s3, 8
    v_add3_u32 v8, v8, s59, v5
    v_bfe_u32 v24, v4, 1, 2
    v_xor_b32 v10, s3, v24
    v_lshl_add_u32 v10, v10, 5, v5
    v_lshl_add_u32 v10, v4, 7, v10
    v_lshrrev_b32 v24, 3, v1
    v_mul_u32_u24 v12, 1152, v24
    v_and_b32 v24, 6, v24
    v_xor_b32 v24, v24, v1
    v_and_b32 v24, 7, v24
    v_lshl_add_u32 v12, v24, 4, v12
    v_add_u32 v12, 1024, v12
    s_lshl_b32 s60, s53, 4
    s_add_u32 s60, s60, s3
    s_add_u32 s60, s60, 0
    s_mul_i32 s30, s60, 9216
    s_mov_b32 s55, s30
    s_mul_i32 s31, s3, 8448
    s_add_u32 s31, s31, 0
    s_mov_b32 m0, s31
    s_add_u32 s31, s31, 1056
    buffer_load_dwordx4 v6, s[40:43], s30 offen nt lds
    s_add_u32 s30, s30, 1152
    s_mov_b32 m0, s31
    s_add_u32 s31, s31, 1056
    buffer_load_dwordx4 v6, s[40:43], s30 offen nt lds
    s_add_u32 s30, s30, 1152
    s_mov_b32 m0, s31
    s_add_u32 s31, s31, 1056
    buffer_load_dwordx4 v6, s[40:43], s30 offen nt lds
    s_add_u32 s30, s30, 1152
    s_mov_b32 m0, s31
    s_add_u32 s31, s31, 1056
    buffer_load_dwordx4 v6, s[40:43], s30 offen nt lds
    s_add_u32 s30, s30, 1152
    s_mov_b32 m0, s31
    s_add_u32 s31, s31, 1056
    buffer_load_dwordx4 v6, s[40:43], s30 offen nt lds
    s_add_u32 s30, s30, 1152
    s_mov_b32 m0, s31
    s_add_u32 s31, s31, 1056
    buffer_load_dwordx4 v6, s[40:43], s30 offen nt lds
    s_add_u32 s30, s30, 1152
    s_mov_b32 m0, s31
    s_add_u32 s31, s31, 1056
    buffer_load_dwordx4 v6, s[40:43], s30 offen nt lds
    s_add_u32 s30, s30, 1152
    s_mov_b32 m0, s31
    s_add_u32 s31, s31, 1056
    buffer_load_dwordx4 v6, s[40:43], s30 offen nt lds
    s_add_u32 s30, s30, 1152
    s_lshl_b32 s31, s3, 10
    s_add_u32 s31, s31, 135168
    s_mov_b32 m0, s31
    s_add_u32 s31, s31, 0
    buffer_load_dwordx4 v12, s[40:43], s55 offen nt lds
    s_add_u32 s55, s55, 0
    s_lshl_b32 s60, s53, 4
    s_add_u32 s60, s60, s3
    s_add_u32 s60, s60, 4
    s_mul_i32 s30, s60, 9216
    s_mov_b32 s55, s30
    s_mul_i32 s31, s3, 8448
    s_add_u32 s31, s31, 33792
    s_mov_b32 m0, s31
    s_add_u32 s31, s31, 1056
    buffer_load_dwordx4 v6, s[40:43], s30 offen nt lds
    s_add_u32 s30, s30, 1152
    s_mov_b32 m0, s31
    s_add_u32 s31, s31, 1056
    buffer_load_dwordx4 v6, s[40:43], s30 offen nt lds
    s_add_u32 s30, s30, 1152
    s_mov_b32 m0, s31
    s_add_u32 s31, s31, 1056
    buffer_load_dwordx4 v6, s[40:43], s30 offen nt lds
    s_add_u32 s30, s30, 1152
    s_mov_b32 m0, s31
    s_add_u32 s31, s31, 1056
    buffer_load_dwordx4 v6, s[40:43], s30 offen nt lds
    s_add_u32 s30, s30, 1152
    s_mov_b32 m0, s31
    s_add_u32 s31, s31, 1056
    buffer_load_dwordx4 v6, s[40:43], s30 offen nt lds
    s_add_u32 s30, s30, 1152
    s_mov_b32 m0, s31
    s_add_u32 s31, s31, 1056
    buffer_load_dwordx4 v6, s[40:43], s30 offen nt lds
    s_add_u32 s30, s30, 1152
    s_mov_b32 m0, s31
    s_add_u32 s31, s31, 1056
    buffer_load_dwordx4 v6, s[40:43], s30 offen nt lds
    s_add_u32 s30, s30, 1152
    s_mov_b32 m0, s31
    s_add_u32 s31, s31, 1056
    buffer_load_dwordx4 v6, s[40:43], s30 offen nt lds
    s_add_u32 s30, s30, 1152
    s_lshl_b32 s31, s3, 10
    s_add_u32 s31, s31, 139264
    s_mov_b32 m0, s31
    s_add_u32 s31, s31, 0
    buffer_load_dwordx4 v12, s[40:43], s55 offen nt lds
    s_add_u32 s55, s55, 0
    s_lshl_b32 s60, s53, 4
    s_add_u32 s60, s60, s3
    s_add_u32 s60, s60, 8
    s_mul_i32 s30, s60, 9216
    s_mov_b32 s55, s30
    s_mul_i32 s31, s3, 8448
    s_add_u32 s31, s31, 67584
    s_mov_b32 m0, s31
    s_add_u32 s31, s31, 1056
    buffer_load_dwordx4 v6, s[40:43], s30 offen nt lds
    s_add_u32 s30, s30, 1152
    s_mov_b32 m0, s31
    s_add_u32 s31, s31, 1056
    buffer_load_dwordx4 v6, s[40:43], s30 offen nt lds
    s_add_u32 s30, s30, 1152
    s_mov_b32 m0, s31
    s_add_u32 s31, s31, 1056
    buffer_load_dwordx4 v6, s[40:43], s30 offen nt lds
    s_add_u32 s30, s30, 1152
    s_mov_b32 m0, s31
    s_add_u32 s31, s31, 1056
    buffer_load_dwordx4 v6, s[40:43], s30 offen nt lds
    s_add_u32 s30, s30, 1152
    s_mov_b32 m0, s31
    s_add_u32 s31, s31, 1056
    buffer_load_dwordx4 v6, s[40:43], s30 offen nt lds
    s_add_u32 s30, s30, 1152
    s_mov_b32 m0, s31
    s_add_u32 s31, s31, 1056
    buffer_load_dwordx4 v6, s[40:43], s30 offen nt lds
    s_add_u32 s30, s30, 1152
    s_mov_b32 m0, s31
    s_add_u32 s31, s31, 1056
    buffer_load_dwordx4 v6, s[40:43], s30 offen nt lds
    s_add_u32 s30, s30, 1152
    s_mov_b32 m0, s31
    s_add_u32 s31, s31, 1056
    buffer_load_dwordx4 v6, s[40:43], s30 offen nt lds
    s_add_u32 s30, s30, 1152
    s_lshl_b32 s31, s3, 10
    s_add_u32 s31, s31, 143360
    s_mov_b32 m0, s31
    s_add_u32 s31, s31, 0
    buffer_load_dwordx4 v12, s[40:43], s55 offen nt lds
    s_add_u32 s55, s55, 0
    s_lshl_b32 s60, s53, 4
    s_add_u32 s60, s60, s3
    s_add_u32 s60, s60, 12
    s_mul_i32 s30, s60, 9216
    s_mov_b32 s55, s30
    s_mul_i32 s31, s3, 8448
    s_add_u32 s31, s31, 101376
    s_mov_b32 m0, s31
    s_add_u32 s31, s31, 1056
    buffer_load_dwordx4 v6, s[40:43], s30 offen nt lds
    s_add_u32 s30, s30, 1152
    s_mov_b32 m0, s31
    s_add_u32 s31, s31, 1056
    buffer_load_dwordx4 v6, s[40:43], s30 offen nt lds
    s_add_u32 s30, s30, 1152
    s_mov_b32 m0, s31
    s_add_u32 s31, s31, 1056
    buffer_load_dwordx4 v6, s[40:43], s30 offen nt lds
    s_add_u32 s30, s30, 1152
    s_mov_b32 m0, s31
    s_add_u32 s31, s31, 1056
    buffer_load_dwordx4 v6, s[40:43], s30 offen nt lds
    s_add_u32 s30, s30, 1152
    s_mov_b32 m0, s31
    s_add_u32 s31, s31, 1056
    buffer_load_dwordx4 v6, s[40:43], s30 offen nt lds
    s_add_u32 s30, s30, 1152
    s_mov_b32 m0, s31
    s_add_u32 s31, s31, 1056
    buffer_load_dwordx4 v6, s[40:43], s30 offen nt lds
    s_add_u32 s30, s30, 1152
    s_mov_b32 m0, s31
    s_add_u32 s31, s31, 1056
    buffer_load_dwordx4 v6, s[40:43], s30 offen nt lds
    s_add_u32 s30, s30, 1152
    s_mov_b32 m0, s31
    s_add_u32 s31, s31, 1056
    buffer_load_dwordx4 v6, s[40:43], s30 offen nt lds
    s_add_u32 s30, s30, 1152
    s_lshl_b32 s31, s3, 10
    s_add_u32 s31, s31, 147456
    s_mov_b32 m0, s31
    s_add_u32 s31, s31, 0
    buffer_load_dwordx4 v12, s[40:43], s55 offen nt lds
    s_add_u32 s55, s55, 0
    v_add_u32 v9, 67584, v8
    v_add_u32 v10, 135168, v10
    v_lshrrev_b32 v24, 2, v2
    v_lshlrev_b32 v24, 4, v24
    v_lshl_add_u32 v24, v3, 6, v24
    v_and_b32 v25, 3, v2
    v_lshl_add_u32 v24, v25, 1, v24
    v_add_u32 v33, 159744, v24
    v_lshlrev_b32 v39, 4, v3
    v_add_u32 v39, 159744, v39
    v_mov_b32 v43, s52
    s_mul_i32 s100, s53, 64
    s_add_u32 s100, s100, 5242880
    s_mul_i32 s58, s3, 3
    v_add_u32 v35, s58, v3
    v_lshrrev_b32 v26, 2, v2
    v_lshl_add_u32 v35, v35, 2, v26
    v_mul_u32_u24 v35, 6656, v35
    v_lshl_add_u32 v35, v5, 1, v35
    v_cmp_eq_u32 s[96:97], 1, v3
    v_cmp_eq_u32 s[98:99], 2, v3
    s_lshl_b32 s58, s53, 12
    s_add_u32 s58, s58, 4980736
    s_waitcnt lgkmcnt(0) vmcnt(0)
    s_barrier
    ds_read_b64_tr_b16 a[0:1], v8 offset:0
    ds_read_b64_tr_b16 a[2:3], v8 offset:16896
    ds_read_b64_tr_b16 a[16:17], v8 offset:32
    ds_read_b64_tr_b16 a[18:19], v8 offset:16928
    ds_read_b64_tr_b16 a[32:33], v8 offset:64
    ds_read_b64_tr_b16 a[34:35], v8 offset:16960
    ds_read_b64_tr_b16 a[48:49], v8 offset:96
    ds_read_b64_tr_b16 a[50:51], v8 offset:16992
    ds_read_b64_tr_b16 a[64:65], v8 offset:128
    ds_read_b64_tr_b16 a[66:67], v8 offset:17024
    ds_read_b64_tr_b16 a[80:81], v8 offset:160
    ds_read_b64_tr_b16 a[82:83], v8 offset:17056
    ds_read_b64_tr_b16 a[96:97], v8 offset:192
    ds_read_b64_tr_b16 a[98:99], v8 offset:17088
    ds_read_b64_tr_b16 a[112:113], v8 offset:224
    ds_read_b64_tr_b16 a[114:115], v8 offset:17120
    ds_read_b64_tr_b16 a[128:129], v10 offset:0
    ds_read_b64_tr_b16 a[130:131], v10 offset:2048
    ds_read_b64_tr_b16 a[4:5], v8 offset:33792
    ds_read_b64_tr_b16 a[6:7], v8 offset:50688
    ds_read_b64_tr_b16 a[20:21], v8 offset:33824
    ds_read_b64_tr_b16 a[22:23], v8 offset:50720
    ds_read_b64_tr_b16 a[36:37], v8 offset:33856
    ds_read_b64_tr_b16 a[38:39], v8 offset:50752
    ds_read_b64_tr_b16 a[52:53], v8 offset:33888
    ds_read_b64_tr_b16 a[54:55], v8 offset:50784
    ds_read_b64_tr_b16 a[68:69], v8 offset:33920
    ds_read_b64_tr_b16 a[70:71], v8 offset:50816
    ds_read_b64_tr_b16 a[84:85], v8 offset:33952
    ds_read_b64_tr_b16 a[86:87], v8 offset:50848
    ds_read_b64_tr_b16 a[100:101], v8 offset:33984
    ds_read_b64_tr_b16 a[102:103], v8 offset:50880
    ds_read_b64_tr_b16 a[116:117], v8 offset:34016
    ds_read_b64_tr_b16 a[118:119], v8 offset:50912
    ds_read_b64_tr_b16 a[132:133], v10 offset:4096
    ds_read_b64_tr_b16 a[134:135], v10 offset:6144
    ds_read_b64_tr_b16 a[8:9], v9 offset:0
    ds_read_b64_tr_b16 a[10:11], v9 offset:16896
    ds_read_b64_tr_b16 a[24:25], v9 offset:32
    ds_read_b64_tr_b16 a[26:27], v9 offset:16928
    ds_read_b64_tr_b16 a[40:41], v9 offset:64
    ds_read_b64_tr_b16 a[42:43], v9 offset:16960
    ds_read_b64_tr_b16 a[56:57], v9 offset:96
    ds_read_b64_tr_b16 a[58:59], v9 offset:16992
    ds_read_b64_tr_b16 a[72:73], v9 offset:128
    ds_read_b64_tr_b16 a[74:75], v9 offset:17024
    ds_read_b64_tr_b16 a[88:89], v9 offset:160
    ds_read_b64_tr_b16 a[90:91], v9 offset:17056
    ds_read_b64_tr_b16 a[104:105], v9 offset:192
    ds_read_b64_tr_b16 a[106:107], v9 offset:17088
    ds_read_b64_tr_b16 a[120:121], v9 offset:224
    ds_read_b64_tr_b16 a[122:123], v9 offset:17120
    ds_read_b64_tr_b16 a[136:137], v10 offset:8192
    ds_read_b64_tr_b16 a[138:139], v10 offset:10240
    ds_read_b64_tr_b16 a[12:13], v9 offset:33792
    ds_read_b64_tr_b16 a[14:15], v9 offset:50688
    ds_read_b64_tr_b16 a[28:29], v9 offset:33824
    ds_read_b64_tr_b16 a[30:31], v9 offset:50720
    ds_read_b64_tr_b16 a[44:45], v9 offset:33856
    ds_read_b64_tr_b16 a[46:47], v9 offset:50752
    ds_read_b64_tr_b16 a[60:61], v9 offset:33888
    ds_read_b64_tr_b16 a[62:63], v9 offset:50784
    ds_read_b64_tr_b16 a[76:77], v9 offset:33920
    ds_read_b64_tr_b16 a[78:79], v9 offset:50816
    ds_read_b64_tr_b16 a[92:93], v9 offset:33952
    ds_read_b64_tr_b16 a[94:95], v9 offset:50848
    ds_read_b64_tr_b16 a[108:109], v9 offset:33984
    ds_read_b64_tr_b16 a[110:111], v9 offset:50880
    ds_read_b64_tr_b16 a[124:125], v9 offset:34016
    ds_read_b64_tr_b16 a[126:127], v9 offset:50912
    ds_read_b64_tr_b16 a[140:141], v10 offset:12288
    ds_read_b64_tr_b16 a[142:143], v10 offset:14336
    s_cmp_lg_u32 s3, 0
    s_cbranch_scc1 L_nohc_17
    s_mov_b32 s57, 0
    buffer_load_dwordx4 v[144:147], v6, s[44:47], s58 offen offset:0 sc1
    buffer_load_dwordx4 v[148:151], v6, s[44:47], s58 offen offset:1024 sc1
    buffer_load_dwordx4 v[152:155], v6, s[44:47], s58 offen offset:2048 sc1
    buffer_load_dwordx4 v[156:159], v6, s[44:47], s58 offen offset:3072 sc1
    buffer_load_dwordx4 v[160:163], v6, s[44:47], s58 offen offset:0 sc1
    buffer_load_dwordx4 v[164:167], v6, s[44:47], s58 offen offset:1024 sc1
    buffer_load_dwordx4 v[168:171], v6, s[44:47], s58 offen offset:2048 sc1
    buffer_load_dwordx4 v[172:175], v6, s[44:47], s58 offen offset:3072 sc1
L_hc_poll_18:
    buffer_load_dwordx4 v[176:179], v6, s[44:47], s58 offen offset:0 sc1
    buffer_load_dwordx4 v[180:183], v6, s[44:47], s58 offen offset:1024 sc1
    buffer_load_dwordx4 v[184:187], v6, s[44:47], s58 offen offset:2048 sc1
    buffer_load_dwordx4 v[188:191], v6, s[44:47], s58 offen offset:3072 sc1
    s_cmp_ge_u32 s57, 12
    s_cselect_b32 s61, 4194304, 0
    s_xor_b32 s58, s58, s61
    s_waitcnt vmcnt(8)
    v_cmp_eq_u32 s[62:63], s52, v147
    v_cmp_eq_u32 vcc, s52, v151
    s_and_b64 s[62:63], s[62:63], vcc
    v_cmp_eq_u32 vcc, s52, v155
    s_and_b64 s[62:63], s[62:63], vcc
    v_cmp_eq_u32 vcc, s52, v159
    s_and_b64 s[62:63], s[62:63], vcc
    s_cmp_eq_u64 s[62:63], exec
    s_cbranch_scc1 L_hc_join_19_0
    buffer_load_dwordx4 v[144:147], v6, s[44:47], s58 offen offset:0 sc1
    buffer_load_dwordx4 v[148:151], v6, s[44:47], s58 offen offset:1024 sc1
    buffer_load_dwordx4 v[152:155], v6, s[44:47], s58 offen offset:2048 sc1
    buffer_load_dwordx4 v[156:159], v6, s[44:47], s58 offen offset:3072 sc1
    s_waitcnt vmcnt(8)
    v_cmp_eq_u32 s[62:63], s52, v163
    v_cmp_eq_u32 vcc, s52, v167
    s_and_b64 s[62:63], s[62:63], vcc
    v_cmp_eq_u32 vcc, s52, v171
    s_and_b64 s[62:63], s[62:63], vcc
    v_cmp_eq_u32 vcc, s52, v175
    s_and_b64 s[62:63], s[62:63], vcc
    s_cmp_eq_u64 s[62:63], exec
    s_cbranch_scc1 L_hc_join_19_1
    buffer_load_dwordx4 v[160:163], v6, s[44:47], s58 offen offset:0 sc1
    buffer_load_dwordx4 v[164:167], v6, s[44:47], s58 offen offset:1024 sc1
    buffer_load_dwordx4 v[168:171], v6, s[44:47], s58 offen offset:2048 sc1
    buffer_load_dwordx4 v[172:175], v6, s[44:47], s58 offen offset:3072 sc1
    s_waitcnt vmcnt(8)
    v_cmp_eq_u32 s[62:63], s52, v179
    v_cmp_eq_u32 vcc, s52, v183
    s_and_b64 s[62:63], s[62:63], vcc
    v_cmp_eq_u32 vcc, s52, v187
    s_and_b64 s[62:63], s[62:63], vcc
    v_cmp_eq_u32 vcc, s52, v191
    s_and_b64 s[62:63], s[62:63], vcc
    s_cmp_eq_u64 s[62:63], exec
    s_cbranch_scc1 L_hc_join_19_2
    s_add_u32 s57, s57, 1
    s_cmp_lt_u32 s57, 1048576
    s_cbranch_scc1 L_hc_poll_18
L_hc_join_19_0:
    v_add_f32 v40, v144, v148
    v_add_f32 v41, v145, v149
    v_add_f32 v42, v152, v156
    v_add_f32 v44, v153, v157
    s_branch L_hc_join_19
L_hc_join_19_1:
    v_add_f32 v40, v160, v164
    v_add_f32 v41, v161, v165
    v_add_f32 v42, v168, v172
    v_add_f32 v44, v169, v173
    s_branch L_hc_join_19
L_hc_join_19_2:
    v_add_f32 v40, v176, v180
    v_add_f32 v41, v177, v181
    v_add_f32 v42, v184, v188
    v_add_f32 v44, v185, v189
L_hc_join_19:
    v_add_f32 v40, v40, v42
    v_add_f32 v41, v41, v44
    v_cvt_pk_bf16_f32 v40, v40, v41
    ds_write_b16 v33, v40
    ds_write_b16_d16_hi v33, v40 offset:8
L_nohc_17:
    s_waitcnt lgkmcnt(0)
    s_barrier
    ds_read_b128 v[112:115], v39 offset:0
    ds_read_b128 v[116:119], v39 offset:64
    ds_read_b128 v[120:123], v39 offset:128
    ds_read_b128 v[124:127], v39 offset:192
    s_waitcnt lgkmcnt(3)
    v_mfma_f32_16x16x32_bf16 v[64:67], v[112:115], a[0:3], 0
    v_mfma_f32_16x16x32_bf16 v[68:71], v[112:115], a[16:19], 0
    v_mfma_f32_16x16x32_bf16 v[72:75], v[112:115], a[32:35], 0
    v_mfma_f32_16x16x32_bf16 v[76:79], v[112:115], a[48:51], 0
    v_mfma_f32_16x16x32_bf16 v[80:83], v[112:115], a[64:67], 0
    v_mfma_f32_16x16x32_bf16 v[84:87], v[112:115], a[80:83], 0
    v_mfma_f32_16x16x32_bf16 v[88:91], v[112:115], a[96:99], 0
    v_mfma_f32_16x16x32_bf16 v[92:95], v[112:115], a[112:115], 0
    v_mfma_f32_16x16x32_bf16 v[96:99], v[112:115], a[128:131], 0
    s_waitcnt lgkmcnt(2)
    v_mfma_f32_16x16x32_bf16 v[64:67], v[116:119], a[4:7], v[64:67]
    v_mfma_f32_16x16x32_bf16 v[68:71], v[116:119], a[20:23], v[68:71]
    v_mfma_f32_16x16x32_bf16 v[72:75], v[116:119], a[36:39], v[72:75]
    v_mfma_f32_16x16x32_bf16 v[76:79], v[116:119], a[52:55], v[76:79]
    v_mfma_f32_16x16x32_bf16 v[80:83], v[116:119], a[68:71], v[80:83]
    v_mfma_f32_16x16x32_bf16 v[84:87], v[116:119], a[84:87], v[84:87]
    v_mfma_f32_16x16x32_bf16 v[88:91], v[116:119], a[100:103], v[88:91]
    v_mfma_f32_16x16x32_bf16 v[92:95], v[116:119], a[116:119], v[92:95]
    v_mfma_f32_16x16x32_bf16 v[96:99], v[116:119], a[132:135], v[96:99]
    s_waitcnt lgkmcnt(1)
    v_mfma_f32_16x16x32_bf16 v[64:67], v[120:123], a[8:11], v[64:67]
    v_mfma_f32_16x16x32_bf16 v[68:71], v[120:123], a[24:27], v[68:71]
    v_mfma_f32_16x16x32_bf16 v[72:75], v[120:123], a[40:43], v[72:75]
    v_mfma_f32_16x16x32_bf16 v[76:79], v[120:123], a[56:59], v[76:79]
    v_mfma_f32_16x16x32_bf16 v[80:83], v[120:123], a[72:75], v[80:83]
    v_mfma_f32_16x16x32_bf16 v[84:87], v[120:123], a[88:91], v[84:87]
    v_mfma_f32_16x16x32_bf16 v[88:91], v[120:123], a[104:107], v[88:91]
    v_mfma_f32_16x16x32_bf16 v[92:95], v[120:123], a[120:123], v[92:95]
    v_mfma_f32_16x16x32_bf16 v[96:99], v[120:123], a[136:139], v[96:99]
    s_waitcnt lgkmcnt(0)
    v_mfma_f32_16x16x32_bf16 v[64:67], v[124:127], a[12:15], v[64:67]
    v_mfma_f32_16x16x32_bf16 v[68:71], v[124:127], a[28:31], v[68:71]
    v_mfma_f32_16x16x32_bf16 v[72:75], v[124:127], a[44:47], v[72:75]
    v_mfma_f32_16x16x32_bf16 v[76:79], v[124:127], a[60:63], v[76:79]
    v_mfma_f32_16x16x32_bf16 v[80:83], v[124:127], a[76:79], v[80:83]
    v_mfma_f32_16x16x32_bf16 v[84:87], v[124:127], a[92:95], v[84:87]
    v_mfma_f32_16x16x32_bf16 v[88:91], v[124:127], a[108:111], v[88:91]
    v_mfma_f32_16x16x32_bf16 v[92:95], v[124:127], a[124:127], v[92:95]
    v_mfma_f32_16x16x32_bf16 v[96:99], v[124:127], a[140:143], v[96:99]
    s_nop 2
    v_cndmask_b32 v40, v64, v76, s[96:97]
    v_cndmask_b32 v41, v68, v80, s[96:97]
    v_cndmask_b32 v42, v72, v84, s[96:97]
    v_cndmask_b32 v40, v40, v88, s[98:99]
    v_cndmask_b32 v41, v41, v92, s[98:99]
    v_cndmask_b32 v42, v42, v96, s[98:99]
    s_mov_b32 exec_hi, 0xffff
    buffer_store_dwordx4 v[40:43], v35, s[44:47], s100 offen sc1
    s_mov_b32 exec_hi, -1
    s_branch L_exit
L_H:
    s_mov_b32 s32, s18
    s_mov_b32 s33, s19
    s_mov_b32 s34, 5308416
    s_mov_b32 s35, 0x20000
    s_mov_b32 s36, s20
    s_mov_b32 s37, s21
    s_mov_b32 s38, 5308416
    s_mov_b32 s39, 0x20000
    s_mov_b32 s40, s22
    s_mov_b32 s41, s23
    s_mov_b32 s42, 5308416
    s_mov_b32 s43, 0x20000
    v_lshrrev_b32 v24, 3, v1
    v_mul_u32_u24 v11, 9216, v24
    v_and_b32 v24, 7, v1
    v_lshl_add_u32 v11, v24, 4, v11
    s_lshl_b32 s59, s3, 10
    s_add_u32 m0, s59, 155648
    s_and_b32 s58, s2, 7
    s_lshr_b32 s59, s58, 2
    s_add_u32 s59, s59, s58
    s_lshl_b32 s59, s59, 10
    s_add_u32 s59, s59, 384
    s_sub_u32 s100, s2, 104
    s_lshr_b32 s100, s100, 3
    s_lshl_b32 s100, s100, 2
    s_add_u32 s100, s100, s3
    s_mul_i32 s60, s100, 73728
    s_add_u32 s30, s59, s60
    s_add_u32 s30, s30, 1769472
    s_mul_i32 s101, s58, 648
    s_add_u32 s101, s101, s100
    s_add_u32 s101, s101, 72
    s_lshl_b32 s101, s101, 10
L_help_20:
    s_add_u32 s55, s30, 0
    buffer_load_dwordx4 v11, s[32:35], s55 offen  lds
    s_add_u32 s55, s30, 0
    buffer_load_dwordx4 v11, s[36:39], s55 offen  lds
    s_add_u32 s55, s30, 884736
    buffer_load_dwordx4 v11, s[32:35], s55 offen  lds
    s_add_u32 s55, s30, 884736
    buffer_load_dwordx4 v11, s[36:39], s55 offen  lds
    s_add_u32 s55, s30, 1769472
    buffer_load_dwordx4 v11, s[32:35], s55 offen  lds
    s_add_u32 s55, s30, 1769472
    buffer_load_dwordx4 v11, s[36:39], s55 offen  lds
    s_add_u32 s55, s30, 2654208
    buffer_load_dwordx4 v11, s[32:35], s55 offen  lds
    s_add_u32 s55, s30, 2654208
    buffer_load_dwordx4 v11, s[36:39], s55 offen  lds
    s_add_u32 s30, s30, 1024
    s_add_u32 s58, s58, 8
    s_cmp_eq_u32 s58, 11
    s_cbranch_scc1 L_help_20
    s_branch L_exit
L_B:
    s_mov_b32 m0, s31
    s_add_u32 s31, s31, 1056
    buffer_load_dwordx4 v6, s[40:43], s30 offen  lds
    s_add_u32 s30, s30, 1024
    s_waitcnt lgkmcnt(0)
    v_mov_b32 v90, 0
    v_mov_b32 v91, 0
    v_mov_b32 v110, 0
    v_mov_b32 v111, 0
    v_mov_b32 v130, 0
    v_mov_b32 v131, 0
    s_waitcnt lgkmcnt(0) vmcnt(2)
    s_barrier
    ds_read_b64_tr_b16 v[100:101], v38 offset:0
    ds_read_b64_tr_b16 v[120:121], v39 offset:0
    ds_read_b64_tr_b16 v[102:103], v38 offset:4096
    ds_read_b64_tr_b16 v[122:123], v39 offset:4096
    ds_read_b64_tr_b16 v[104:105], v38 offset:8192
    ds_read_b64_tr_b16 v[124:125], v39 offset:8192
    ds_read_b64_tr_b16 v[106:107], v38 offset:12288
    ds_read_b64_tr_b16 v[126:127], v39 offset:12288
    ds_read_b64_tr_b16 v[108:109], v38 offset:16384
    ds_read_b64_tr_b16 v[128:129], v39 offset:16384
    s_waitcnt lgkmcnt(7)
    v_mfma_f32_16x16x32_bf16 v[72:75], v[80:83], v[100:103], 0
    s_waitcnt lgkmcnt(6)
    v_mfma_f32_16x16x32_bf16 v[76:79], v[80:83], v[120:123], 0
    s_waitcnt lgkmcnt(3)
    v_mfma_f32_16x16x32_bf16 v[72:75], v[84:87], v[104:107], v[72:75]
    s_waitcnt lgkmcnt(2)
    v_mfma_f32_16x16x32_bf16 v[76:79], v[84:87], v[124:127], v[76:79]
    s_waitcnt lgkmcnt(1)
    v_mfma_f32_16x16x32_bf16 v[72:75], v[88:91], v[108:111], v[72:75]
    s_waitcnt lgkmcnt(0)
    v_mfma_f32_16x16x32_bf16 v[76:79], v[88:91], v[128:131], v[76:79]
    s_mov_b64 exec, 0xffff
    s_nop 4
    v_mov_b32 v68, v72
    s_nop 0
    v_mov_b32 v69, v76
    s_add_u32 s61, s58, 4194304
    buffer_store_dwordx4 v[68:71], v6, s[44:47], s61 offen
    buffer_store_dwordx4 v[68:71], v6, s[44:47], s58 offen sc1
    s_mov_b64 exec, -1
    s_mov_b32 m0, s31
    s_add_u32 s31, s31, 1056
    buffer_load_dwordx4 v6, s[40:43], s30 offen  lds
    s_add_u32 s30, s30, 1024
    s_mov_b32 m0, s31
    s_add_u32 s31, s31, 1056
    buffer_load_dwordx4 v6, s[40:43], s30 offen  lds
    s_add_u32 s30, s30, 1024
    s_mov_b32 m0, s31
    s_add_u32 s31, s31, 1056
    buffer_load_dwordx4 v6, s[40:43], s30 offen  lds
    s_add_u32 s30, s30, 1024
    s_mov_b32 m0, s31
    s_add_u32 s31, s31, 1056
    buffer_load_dwordx4 v6, s[40:43], s30 offen  lds
    s_add_u32 s30, s30, 1024
    s_mov_b32 m0, s31
    s_add_u32 s31, s31, 1056
    buffer_load_dwordx4 v6, s[40:43], s30 offen  lds
    s_add_u32 s30, s30, 1024
    s_mov_b32 m0, s31
    s_add_u32 s31, s31, 1056
    buffer_load_dwordx4 v6, s[40:43], s30 offen  lds
    s_add_u32 s30, s30, 1024
    s_mov_b32 m0, s31
    s_add_u32 s31, s31, 1056
    buffer_load_dwordx4 v6, s[40:43], s30 offen  lds
    s_add_u32 s30, s30, 1024
    s_add_u32 s30, s30, 24576
    s_mov_b32 s36, s12
    s_mov_b32 s37, s13
    s_mov_b32 s38, 4194304
    s_mov_b32 s39, 0x20000
    s_and_b32 s54, s54, 3
    v_mul_u32_u24 v8, 1056, v2
    v_lshl_add_u32 v8, v3, 4, v8
    s_mul_i32 s58, s3, 16896
    v_add_u32 v8, s58, v8
    v_add_u32 v62, 67584, v8
    v_mul_u32_u24 v9, 1056, v4
    s_lshl_b32 s58, s3, 8
    v_add3_u32 v9, v9, v5, s58
    v_add_u32 v10, 67584, v9
    v_mul_u32_u24 v24, 1536, v2
    v_xor_b32 v25, v3, v2
    v_lshl_add_u32 v44, v25, 4, v24
    v_add_u32 v44, 135168, v44
    v_xor_b32 v45, 64, v44
    v_xor_b32 v46, 128, v44
    v_xor_b32 v47, 192, v44
    s_mul_i32 s100, s3, 6144
    s_add_u32 s55, s100, 135168
    v_add3_u32 v43, v6, s55, 12
    v_mul_u32_u24 v11, 393216, v3
    v_lshrrev_b32 v24, 3, v2
    v_mul_u32_u24 v12, 98304, v24
    v_and_b32 v25, 7, v2
    v_lshl_add_u32 v12, v25, 4, v12
    v_add3_u32 v12, v12, v11, 64
    v_add_u32 v12, 192, v12
    v_lshl_add_u32 v11, v2, 4, v11
    v_lshlrev_b32 v25, 2, v3
    v_add_lshl_u32 v7, v25, v24, 2
    s_bfe_u32 s60, s2, 0x10003
    s_mul_i32 s61, s60, 24576
    s_add_u32 s100, s100, s61
    s_add_u32 s100, s100, 327680
    s_mul_i32 s101, s101, 384
    s_mul_i32 s61, s60, 1572864
    s_add_u32 s101, s101, s61
    s_mul_i32 s61, s3, 24576
    s_add_u32 s101, s101, s61
    s_add_u32 s101, s101, 1015808
    s_lshl_b32 s58, s3, 2
    v_add_u32 v24, 0, v1
    v_mul_u32_u24 v25, 683, v24
    v_lshrrev_b32 v25, 16, v25
    v_add_u32 v25, s58, v25
    v_xor_b32 v24, v24, v25
    v_lshlrev_b32 v48, 4, v24
    v_add_u32 v24, 64, v1
    v_mul_u32_u24 v25, 683, v24
    v_lshrrev_b32 v25, 16, v25
    v_add_u32 v25, s58, v25
    v_xor_b32 v24, v24, v25
    v_lshlrev_b32 v49, 4, v24
    v_add_u32 v24, 128, v1
    v_mul_u32_u24 v25, 683, v24
    v_lshrrev_b32 v25, 16, v25
    v_add_u32 v25, s58, v25
    v_xor_b32 v24, v24, v25
    v_lshlrev_b32 v50, 4, v24
    v_add_u32 v24, 192, v1
    v_mul_u32_u24 v25, 683, v24
    v_lshrrev_b32 v25, 16, v25
    v_add_u32 v25, s58, v25
    v_xor_b32 v24, v24, v25
    v_lshlrev_b32 v51, 4, v24
    v_add_u32 v24, 256, v1
    v_mul_u32_u24 v25, 683, v24
    v_lshrrev_b32 v25, 16, v25
    v_add_u32 v25, s58, v25
    v_xor_b32 v24, v24, v25
    v_lshlrev_b32 v52, 4, v24
    v_add_u32 v24, 320, v1
    v_mul_u32_u24 v25, 683, v24
    v_lshrrev_b32 v25, 16, v25
    v_add_u32 v25, s58, v25
    v_xor_b32 v24, v24, v25
    v_lshlrev_b32 v53, 4, v24
    v_lshlrev_b32 v14, 4, v2
    v_add_u32 v14, 67584, v14
    v_add_u32 v15, s58, v14
    v_and_b32 v24, 1, v2
    v_cmp_eq_u32 s[96:97], 1, v24
    v_cmp_lt_u32 s[98:99], 7, v2
    v_mov_b32 v168, 0x3f803f80
    v_mov_b32 v169, 0x3f803f80
    v_mov_b32 v170, 0x3f803f80
    v_mov_b32 v171, 0x3f803f80
    s_add_u32 s60, s3, 0
    s_and_b32 s60, s60, 3
    s_lshl_b32 s60, s60, 10
    s_add_u32 s60, s60, 68096
    v_add_u32 v16, s60, v6
    s_add_u32 s60, s3, 1
    s_and_b32 s60, s60, 3
    s_lshl_b32 s60, s60, 10
    s_add_u32 s60, s60, 68096
    v_add_u32 v17, s60, v6
    s_add_u32 s60, s3, 2
    s_and_b32 s60, s60, 3
    s_lshl_b32 s60, s60, 10
    s_add_u32 s60, s60, 68096
    v_add_u32 v18, s60, v6
    s_add_u32 s60, s3, 3
    s_and_b32 s60, s60, 3
    s_lshl_b32 s60, s60, 10
    s_add_u32 s60, s60, 68096
    v_add_u32 v19, s60, v6
    v_mov_b32 v147, s52
    v_mov_b32 v151, s52
    v_mov_b32 v155, s52
    v_mov_b32 v159, s52
    v_mov_b32 v163, s52
    v_mov_b32 v167, s52
    s_and_b32 s16, s2, 15
    s_lshl_b32 s16, s16, 7
    s_add_u32 s16, s16, 45056
    v_and_b32 v24, 7, v1
    s_and_b32 s60, s2, 4
    s_lshl_b32 s60, s60, 1
    v_add_u32 v25, s60, v24
    v_lshlrev_b32 v25, 7, v25
    v_add_u32 v25, 45056, v25
    s_and_b32 s60, s2, 7
    v_cmp_eq_u32 vcc, s60, v24
    s_and_b32 s60, s2, 8
    s_lshl_b32 s60, s60, 8
    s_add_u32 s60, s60, 40960
    v_mov_b32 v24, s60
    v_cndmask_b32 v137, v25, v24, vcc
    v_lshrrev_b32 v24, 1, v1
    s_mul_i32 s60, s3, 28
    v_add_u32 v24, s60, v24
    v_and_b32 v25, 1, v1
    v_lshlrev_b32 v25, 7, v25
    v_lshl_add_u32 v140, v24, 13, v25
    v_and_b32 v24, 1, v3
    v_lshlrev_b32 v25, 1, v24
    v_xor_b32 v25, v25, v1
    v_and_b32 v25, 3, v25
    v_lshlrev_b32 v25, 4, v25
    v_lshl_add_u32 v13, v4, 13, v25
    s_lshl_b32 s60, s3, 13
    v_lshl_add_u32 v36, v4, 6, s60
    v_lshl_add_u32 v36, v24, 5, v36
    v_add_u32 v36, v36, v5
    v_xor_b32 v37, 32, v36
    v_mov_b32 v138, 0
    s_mov_b32 s17, 0
    v_add_u32 v25, 0, v1
    v_mul_u32_u24 v26, 2731, v25
    v_lshrrev_b32 v26, 16, v26
    v_and_b32 v26, 6, v26
    v_xor_b32 v25, v25, v26
    v_lshlrev_b32 v54, 4, v25
    v_add_u32 v25, 64, v1
    v_mul_u32_u24 v26, 2731, v25
    v_lshrrev_b32 v26, 16, v26
    v_and_b32 v26, 6, v26
    v_xor_b32 v25, v25, v26
    v_lshlrev_b32 v55, 4, v25
    v_add_u32 v25, 128, v1
    v_mul_u32_u24 v26, 2731, v25
    v_lshrrev_b32 v26, 16, v26
    v_and_b32 v26, 6, v26
    v_xor_b32 v25, v25, v26
    v_lshlrev_b32 v56, 4, v25
    v_bfe_u32 v25, v1, 1, 2
    v_mul_u32_u24 v57, 384, v1
    v_lshl_add_u32 v57, v25, 5, v57
    v_add_u32 v57, 135432, v57
    s_lshl_b32 s58, s3, 7
    s_add_u32 s58, s58, 101376
    v_and_b32 v25, 0x23, v1
    v_bfe_u32 v26, v1, 2, 2
    v_lshl_add_u32 v25, v26, 3, v25
    v_bfe_u32 v26, v1, 4, 1
    v_lshl_add_u32 v25, v26, 2, v25
    v_lshl_add_u32 v58, v25, 1, s58
    v_lshl_add_u32 v59, v3, 4, s58
    v_bfe_u32 v24, v4, 1, 2
    v_mul_u32_u24 v25, 384, v4
    v_add_u32 v25, v25, v5
    v_bfe_u32 v27, v2, 1, 2
    v_and_b32 v28, 1, v2
    s_mul_i32 s58, s3, 3
    s_add_u32 s58, s58, 0
    s_and_b32 s59, s58, 3
    s_lshr_b32 s60, s58, 2
    s_lshl_b32 s60, s60, 7
    s_add_u32 s60, s60, 135168
    v_xor_b32 v26, s59, v24
    v_lshl_add_u32 v26, v26, 5, v25
    v_add_u32 v128, s60, v26
    s_lshl_b32 s59, s58, 1
    v_lshrrev_b32 v26, 3, v2
    v_add_u32 v26, s59, v26
    v_lshl_add_u32 v29, v27, 1, v28
    v_lshl_add_u32 v29, v29, 4, v26
    v_lshl_add_u32 v30, v27, 3, v26
    v_lshl_add_u32 v30, v28, 4, v30
    v_add_u32 v30, 80, v30
    s_cmp_lt_u32 s58, 8
    s_cselect_b64 vcc, -1, 0
    s_cselect_b32 s59, 3, 2
    v_cndmask_b32 v29, v30, v29, vcc
    v_and_b32 v30, 0x63, v29
    v_bfe_u32 v26, v29, 2, 2
    v_lshl_add_u32 v30, v26, 3, v30
    v_bfe_u32 v26, v29, 4, 1
    v_lshl_add_u32 v30, v26, 2, v30
    v_lshlrev_b32 v29, 1, v30
    v_add_u32 v29, 101888, v29
    v_cmp_gt_u32 vcc, s59, v27
    v_mov_b32 v30, 102160
    s_nop 0
    v_cndmask_b32 v131, v30, v29, vcc
    s_mul_i32 s58, s3, 3
    s_add_u32 s58, s58, 1
    s_and_b32 s59, s58, 3
    s_lshr_b32 s60, s58, 2
    s_lshl_b32 s60, s60, 7
    s_add_u32 s60, s60, 135168
    v_xor_b32 v26, s59, v24
    v_lshl_add_u32 v26, v26, 5, v25
    v_add_u32 v129, s60, v26
    s_lshl_b32 s59, s58, 1
    v_lshrrev_b32 v26, 3, v2
    v_add_u32 v26, s59, v26
    v_lshl_add_u32 v29, v27, 1, v28
    v_lshl_add_u32 v29, v29, 4, v26
    v_lshl_add_u32 v30, v27, 3, v26
    v_lshl_add_u32 v30, v28, 4, v30
    v_add_u32 v30, 80, v30
    s_cmp_lt_u32 s58, 8
    s_cselect_b64 vcc, -1, 0
    s_cselect_b32 s59, 3, 2
    v_cndmask_b32 v29, v30, v29, vcc
    v_and_b32 v30, 0x63, v29
    v_bfe_u32 v26, v29, 2, 2
    v_lshl_add_u32 v30, v26, 3, v30
    v_bfe_u32 v26, v29, 4, 1
    v_lshl_add_u32 v30, v26, 2, v30
    v_lshlrev_b32 v29, 1, v30
    v_add_u32 v29, 101888, v29
    v_cmp_gt_u32 vcc, s59, v27
    v_mov_b32 v30, 102160
    s_nop 0
    v_cndmask_b32 v132, v30, v29, vcc
    s_mul_i32 s58, s3, 3
    s_add_u32 s58, s58, 2
    s_and_b32 s59, s58, 3
    s_lshr_b32 s60, s58, 2
    s_lshl_b32 s60, s60, 7
    s_add_u32 s60, s60, 135168
    v_xor_b32 v26, s59, v24
    v_lshl_add_u32 v26, v26, 5, v25
    v_add_u32 v130, s60, v26
    s_lshl_b32 s59, s58, 1
    v_lshrrev_b32 v26, 3, v2
    v_add_u32 v26, s59, v26
    v_lshl_add_u32 v29, v27, 1, v28
    v_lshl_add_u32 v29, v29, 4, v26
    v_lshl_add_u32 v30, v27, 3, v26
    v_lshl_add_u32 v30, v28, 4, v30
    v_add_u32 v30, 80, v30
    s_cmp_lt_u32 s58, 8
    s_cselect_b64 vcc, -1, 0
    s_cselect_b32 s59, 3, 2
    v_cndmask_b32 v29, v30, v29, vcc
    v_and_b32 v30, 0x63, v29
    v_bfe_u32 v26, v29, 2, 2
    v_lshl_add_u32 v30, v26, 3, v30
    v_bfe_u32 v26, v29, 4, 1
    v_lshl_add_u32 v30, v26, 2, v30
    v_lshlrev_b32 v29, 1, v30
    v_add_u32 v29, 101888, v29
    v_cmp_gt_u32 vcc, s59, v27
    v_mov_b32 v30, 102160
    s_nop 0
    v_cndmask_b32 v133, v30, v29, vcc
    v_lshlrev_b32 v26, 2, v2
    v_add_u32 v26, 102096, v26
    v_lshrrev_b32 v27, 1, v2
    v_cmp_eq_u32 vcc, 6, v27
    v_mov_b32 v30, 102160
    s_cmp_eq_u32 s3, 2
    s_cselect_b64 s[62:63], -1, 0
    s_and_b64 vcc, vcc, s[62:63]
    v_cndmask_b32 v134, v30, v26, vcc
    v_lshlrev_b32 v135, 4, v3
    v_add_u32 v135, 101888, v135
    v_mov_b32 v136, 102144
    s_cmp_ge_u32 s2, 176
    s_cbranch_scc1 L_nw_21
    s_sub_u32 s27, s2, 128
    s_lshl2_add_u32 s27, s27, s3
    s_mul_i32 s27, s27, 1664
    s_add_u32 s27, s27, 5242880
    v_lshlrev_b32 v190, 7, v1
    v_min_u32 v190, 1536, v190
    buffer_load_dword v191, v190, s[44:47], s27 offen sc1
L_nw_21:
    s_mul_i32 s31, s3, 8448
    s_add_u32 s31, s31, 33792
    s_mov_b32 m0, s31
    s_add_u32 s31, s31, 1056
    buffer_load_dwordx4 v6, s[40:43], s30 offen  lds
    s_add_u32 s30, s30, 1024
    s_mov_b32 m0, s31
    s_add_u32 s31, s31, 1056
    buffer_load_dwordx4 v6, s[40:43], s30 offen  lds
    s_add_u32 s30, s30, 1024
    s_mov_b32 m0, s31
    s_add_u32 s31, s31, 1056
    buffer_load_dwordx4 v6, s[40:43], s30 offen  lds
    s_add_u32 s30, s30, 1024
    s_mov_b32 m0, s31
    s_add_u32 s31, s31, 1056
    buffer_load_dwordx4 v6, s[40:43], s30 offen  lds
    s_add_u32 s30, s30, 1024
    s_mov_b32 m0, s31
    s_add_u32 s31, s31, 1056
    buffer_load_dwordx4 v6, s[40:43], s30 offen  lds
    s_add_u32 s30, s30, 1024
    s_mov_b32 m0, s31
    s_add_u32 s31, s31, 1056
    buffer_load_dwordx4 v6, s[40:43], s30 offen  lds
    s_add_u32 s30, s30, 1024
    s_mov_b32 m0, s31
    s_add_u32 s31, s31, 1056
    buffer_load_dwordx4 v6, s[40:43], s30 offen  lds
    s_add_u32 s30, s30, 1024
    s_mov_b32 m0, s31
    s_add_u32 s31, s31, 1056
    buffer_load_dwordx4 v6, s[40:43], s30 offen  lds
    s_add_u32 s30, s30, 1024
    s_add_u32 s30, s30, 24576
    s_bitcmp1_b32 s2, 3
    s_cselect_b32 s59, 131072, 0
    s_sub_u32 s30, s30, s59
    v_lshlrev_b32 v80, 7, v1
    v_min_u32 v80, 384, v80
    s_bfe_u32 s60, s2, 0x10003
    s_lshl_b32 s60, s60, 2
    s_add_u32 s60, s60, s3
    s_lshl_b32 s60, s60, 9
    s_add_u32 s60, s60, 40960
    s_mov_b32 s4, s60
    s_waitcnt lgkmcnt(0) vmcnt(8)
    s_barrier
    s_mul_i32 s31, s3, 8448
    s_add_u32 s31, s31, 67584
    s_mov_b32 m0, s31
    s_add_u32 s31, s31, 1056
    buffer_load_dwordx4 v6, s[40:43], s30 offen  lds
    s_add_u32 s30, s30, 1024
    s_mov_b32 m0, s31
    s_add_u32 s31, s31, 1056
    buffer_load_dwordx4 v6, s[40:43], s30 offen  lds
    s_add_u32 s30, s30, 1024
    s_mov_b32 m0, s31
    s_add_u32 s31, s31, 1056
    buffer_load_dwordx4 v6, s[40:43], s30 offen  lds
    s_add_u32 s30, s30, 1024
    s_mov_b32 m0, s31
    s_add_u32 s31, s31, 1056
    buffer_load_dwordx4 v6, s[40:43], s30 offen  lds
    s_add_u32 s30, s30, 1024
    s_mov_b32 m0, s31
    s_add_u32 s31, s31, 1056
    buffer_load_dwordx4 v6, s[40:43], s30 offen  lds
    s_add_u32 s30, s30, 1024
    s_mov_b32 m0, s31
    s_add_u32 s31, s31, 1056
    buffer_load_dwordx4 v6, s[40:43], s30 offen  lds
    s_add_u32 s30, s30, 1024
    s_mov_b32 m0, s31
    s_add_u32 s31, s31, 1056
    buffer_load_dwordx4 v6, s[40:43], s30 offen  lds
    s_add_u32 s30, s30, 1024
    s_mov_b32 m0, s31
    s_add_u32 s31, s31, 1056
    buffer_load_dwordx4 v6, s[40:43], s30 offen  lds
    s_add_u32 s30, s30, 1024
    s_add_u32 s30, s30, 24576
    s_lshr_b32 s61, s3, 1
    s_cmp_lg_u32 s61, 0
    s_cbranch_scc1 L_nq_22
    ds_read_b128 a[0:3], v8 offset:0
    ds_read_b128 a[4:7], v8 offset:64
    ds_read_b128 a[8:11], v8 offset:128
    ds_read_b128 a[12:15], v8 offset:192
    ds_read_b128 a[16:19], v8 offset:256
    ds_read_b128 a[20:23], v8 offset:320
    ds_read_b128 a[24:27], v8 offset:384
    ds_read_b128 a[28:31], v8 offset:448
    ds_read_b128 a[32:35], v8 offset:512
    ds_read_b128 a[36:39], v8 offset:576
    ds_read_b128 a[40:43], v8 offset:640
    ds_read_b128 a[44:47], v8 offset:704
    ds_read_b128 a[48:51], v8 offset:768
    ds_read_b128 a[52:55], v8 offset:832
    ds_read_b128 a[56:59], v8 offset:896
    ds_read_b128 a[60:63], v8 offset:960
L_nq_22:
    s_cmp_lg_u32 s3, 0
    s_cbranch_scc1 L_pv_23
    ds_read_b64_tr_b16 a[128:129], v9 offset:0
    ds_read_b64_tr_b16 a[144:145], v9 offset:32
    ds_read_b64_tr_b16 a[160:161], v9 offset:64
    ds_read_b64_tr_b16 a[176:177], v9 offset:96
    ds_read_b64_tr_b16 a[192:193], v9 offset:128
    ds_read_b64_tr_b16 a[208:209], v9 offset:160
    ds_read_b64_tr_b16 a[224:225], v9 offset:192
    ds_read_b64_tr_b16 a[240:241], v9 offset:224
    ds_read_b64_tr_b16 a[132:133], v9 offset:16896
    ds_read_b64_tr_b16 a[148:149], v9 offset:16928
    ds_read_b64_tr_b16 a[164:165], v9 offset:16960
    ds_read_b64_tr_b16 a[180:181], v9 offset:16992
    ds_read_b64_tr_b16 a[196:197], v9 offset:17024
    ds_read_b64_tr_b16 a[212:213], v9 offset:17056
    ds_read_b64_tr_b16 a[228:229], v9 offset:17088
    ds_read_b64_tr_b16 a[244:245], v9 offset:17120
L_pv_23:
    s_cmp_lg_u32 s3, 1
    s_cbranch_scc1 L_pv_24
    ds_read_b64_tr_b16 a[140:141], v9 offset:0
    ds_read_b64_tr_b16 a[156:157], v9 offset:32
    ds_read_b64_tr_b16 a[172:173], v9 offset:64
    ds_read_b64_tr_b16 a[188:189], v9 offset:96
    ds_read_b64_tr_b16 a[204:205], v9 offset:128
    ds_read_b64_tr_b16 a[220:221], v9 offset:160
    ds_read_b64_tr_b16 a[236:237], v9 offset:192
    ds_read_b64_tr_b16 a[252:253], v9 offset:224
    ds_read_b64_tr_b16 a[128:129], v9 offset:16896
    ds_read_b64_tr_b16 a[144:145], v9 offset:16928
    ds_read_b64_tr_b16 a[160:161], v9 offset:16960
    ds_read_b64_tr_b16 a[176:177], v9 offset:16992
    ds_read_b64_tr_b16 a[192:193], v9 offset:17024
    ds_read_b64_tr_b16 a[208:209], v9 offset:17056
    ds_read_b64_tr_b16 a[224:225], v9 offset:17088
    ds_read_b64_tr_b16 a[240:241], v9 offset:17120
L_pv_24:
    s_cmp_lg_u32 s3, 2
    s_cbranch_scc1 L_pv_25
    ds_read_b64_tr_b16 a[136:137], v9 offset:0
    ds_read_b64_tr_b16 a[152:153], v9 offset:32
    ds_read_b64_tr_b16 a[168:169], v9 offset:64
    ds_read_b64_tr_b16 a[184:185], v9 offset:96
    ds_read_b64_tr_b16 a[200:201], v9 offset:128
    ds_read_b64_tr_b16 a[216:217], v9 offset:160
    ds_read_b64_tr_b16 a[232:233], v9 offset:192
    ds_read_b64_tr_b16 a[248:249], v9 offset:224
    ds_read_b64_tr_b16 a[140:141], v9 offset:16896
    ds_read_b64_tr_b16 a[156:157], v9 offset:16928
    ds_read_b64_tr_b16 a[172:173], v9 offset:16960
    ds_read_b64_tr_b16 a[188:189], v9 offset:16992
    ds_read_b64_tr_b16 a[204:205], v9 offset:17024
    ds_read_b64_tr_b16 a[220:221], v9 offset:17056
    ds_read_b64_tr_b16 a[236:237], v9 offset:17088
    ds_read_b64_tr_b16 a[252:253], v9 offset:17120
L_pv_25:
    s_cmp_lg_u32 s3, 3
    s_cbranch_scc1 L_pv_26
    ds_read_b64_tr_b16 a[132:133], v9 offset:0
    ds_read_b64_tr_b16 a[148:149], v9 offset:32
    ds_read_b64_tr_b16 a[164:165], v9 offset:64
    ds_read_b64_tr_b16 a[180:181], v9 offset:96
    ds_read_b64_tr_b16 a[196:197], v9 offset:128
    ds_read_b64_tr_b16 a[212:213], v9 offset:160
    ds_read_b64_tr_b16 a[228:229], v9 offset:192
    ds_read_b64_tr_b16 a[244:245], v9 offset:224
    ds_read_b64_tr_b16 a[136:137], v9 offset:16896
    ds_read_b64_tr_b16 a[152:153], v9 offset:16928
    ds_read_b64_tr_b16 a[168:169], v9 offset:16960
    ds_read_b64_tr_b16 a[184:185], v9 offset:16992
    ds_read_b64_tr_b16 a[200:201], v9 offset:17024
    ds_read_b64_tr_b16 a[216:217], v9 offset:17056
    ds_read_b64_tr_b16 a[232:233], v9 offset:17088
    ds_read_b64_tr_b16 a[248:249], v9 offset:17120
L_pv_26:
    s_waitcnt lgkmcnt(0) vmcnt(8)
    s_barrier
    s_mul_i32 s31, s3, 8448
    s_add_u32 s31, s31, 101376
    s_mov_b32 m0, s31
    s_add_u32 s31, s31, 1056
    buffer_load_dwordx4 v6, s[40:43], s30 offen  lds
    s_add_u32 s30, s30, 1024
    s_mov_b32 m0, s31
    s_add_u32 s31, s31, 1056
    buffer_load_dwordx4 v6, s[40:43], s30 offen  lds
    s_add_u32 s30, s30, 1024
    s_mov_b32 m0, s31
    s_add_u32 s31, s31, 1056
    buffer_load_dwordx4 v6, s[40:43], s30 offen  lds
    s_add_u32 s30, s30, 1024
    s_mov_b32 m0, s31
    s_add_u32 s31, s31, 1056
    buffer_load_dwordx4 v6, s[40:43], s30 offen  lds
    s_add_u32 s30, s30, 1024
    s_mov_b32 m0, s31
    s_add_u32 s31, s31, 1056
    buffer_load_dwordx4 v6, s[40:43], s30 offen  lds
    s_add_u32 s30, s30, 1024
    s_mov_b32 m0, s31
    s_add_u32 s31, s31, 1056
    buffer_load_dwordx4 v6, s[40:43], s30 offen  lds
    s_add_u32 s30, s30, 1024
    s_mov_b32 m0, s31
    s_add_u32 s31, s31, 1056
    buffer_load_dwordx4 v6, s[40:43], s30 offen  lds
    s_add_u32 s30, s30, 1024
    s_mov_b32 m0, s31
    s_add_u32 s31, s31, 1056
    buffer_load_dwordx4 v6, s[40:43], s30 offen  lds
    s_add_u32 s30, s30, 1024
    s_add_u32 s30, s30, 24576
    s_lshr_b32 s61, s3, 1
    s_cmp_lg_u32 s61, 1
    s_cbranch_scc1 L_nq_27
    ds_read_b128 a[0:3], v8 offset:0
    ds_read_b128 a[4:7], v8 offset:64
    ds_read_b128 a[8:11], v8 offset:128
    ds_read_b128 a[12:15], v8 offset:192
    ds_read_b128 a[16:19], v8 offset:256
    ds_read_b128 a[20:23], v8 offset:320
    ds_read_b128 a[24:27], v8 offset:384
    ds_read_b128 a[28:31], v8 offset:448
    ds_read_b128 a[32:35], v8 offset:512
    ds_read_b128 a[36:39], v8 offset:576
    ds_read_b128 a[40:43], v8 offset:640
    ds_read_b128 a[44:47], v8 offset:704
    ds_read_b128 a[48:51], v8 offset:768
    ds_read_b128 a[52:55], v8 offset:832
    ds_read_b128 a[56:59], v8 offset:896
    ds_read_b128 a[60:63], v8 offset:960
L_nq_27:
    s_cmp_lg_u32 s3, 0
    s_cbranch_scc1 L_pv_28
    ds_read_b64_tr_b16 a[136:137], v9 offset:33792
    ds_read_b64_tr_b16 a[152:153], v9 offset:33824
    ds_read_b64_tr_b16 a[168:169], v9 offset:33856
    ds_read_b64_tr_b16 a[184:185], v9 offset:33888
    ds_read_b64_tr_b16 a[200:201], v9 offset:33920
    ds_read_b64_tr_b16 a[216:217], v9 offset:33952
    ds_read_b64_tr_b16 a[232:233], v9 offset:33984
    ds_read_b64_tr_b16 a[248:249], v9 offset:34016
    ds_read_b64_tr_b16 a[140:141], v9 offset:50688
    ds_read_b64_tr_b16 a[156:157], v9 offset:50720
    ds_read_b64_tr_b16 a[172:173], v9 offset:50752
    ds_read_b64_tr_b16 a[188:189], v9 offset:50784
    ds_read_b64_tr_b16 a[204:205], v9 offset:50816
    ds_read_b64_tr_b16 a[220:221], v9 offset:50848
    ds_read_b64_tr_b16 a[236:237], v9 offset:50880
    ds_read_b64_tr_b16 a[252:253], v9 offset:50912
L_pv_28:
    s_cmp_lg_u32 s3, 1
    s_cbranch_scc1 L_pv_29
    ds_read_b64_tr_b16 a[132:133], v9 offset:33792
    ds_read_b64_tr_b16 a[148:149], v9 offset:33824
    ds_read_b64_tr_b16 a[164:165], v9 offset:33856
    ds_read_b64_tr_b16 a[180:181], v9 offset:33888
    ds_read_b64_tr_b16 a[196:197], v9 offset:33920
    ds_read_b64_tr_b16 a[212:213], v9 offset:33952
    ds_read_b64_tr_b16 a[228:229], v9 offset:33984
    ds_read_b64_tr_b16 a[244:245], v9 offset:34016
    ds_read_b64_tr_b16 a[136:137], v9 offset:50688
    ds_read_b64_tr_b16 a[152:153], v9 offset:50720
    ds_read_b64_tr_b16 a[168:169], v9 offset:50752
    ds_read_b64_tr_b16 a[184:185], v9 offset:50784
    ds_read_b64_tr_b16 a[200:201], v9 offset:50816
    ds_read_b64_tr_b16 a[216:217], v9 offset:50848
    ds_read_b64_tr_b16 a[232:233], v9 offset:50880
    ds_read_b64_tr_b16 a[248:249], v9 offset:50912
L_pv_29:
    s_cmp_lg_u32 s3, 2
    s_cbranch_scc1 L_pv_30
    ds_read_b64_tr_b16 a[128:129], v9 offset:33792
    ds_read_b64_tr_b16 a[144:145], v9 offset:33824
    ds_read_b64_tr_b16 a[160:161], v9 offset:33856
    ds_read_b64_tr_b16 a[176:177], v9 offset:33888
    ds_read_b64_tr_b16 a[192:193], v9 offset:33920
    ds_read_b64_tr_b16 a[208:209], v9 offset:33952
    ds_read_b64_tr_b16 a[224:225], v9 offset:33984
    ds_read_b64_tr_b16 a[240:241], v9 offset:34016
    ds_read_b64_tr_b16 a[132:133], v9 offset:50688
    ds_read_b64_tr_b16 a[148:149], v9 offset:50720
    ds_read_b64_tr_b16 a[164:165], v9 offset:50752
    ds_read_b64_tr_b16 a[180:181], v9 offset:50784
    ds_read_b64_tr_b16 a[196:197], v9 offset:50816
    ds_read_b64_tr_b16 a[212:213], v9 offset:50848
    ds_read_b64_tr_b16 a[228:229], v9 offset:50880
    ds_read_b64_tr_b16 a[244:245], v9 offset:50912
L_pv_30:
    s_cmp_lg_u32 s3, 3
    s_cbranch_scc1 L_pv_31
    ds_read_b64_tr_b16 a[140:141], v9 offset:33792
    ds_read_b64_tr_b16 a[156:157], v9 offset:33824
    ds_read_b64_tr_b16 a[172:173], v9 offset:33856
    ds_read_b64_tr_b16 a[188:189], v9 offset:33888
    ds_read_b64_tr_b16 a[204:205], v9 offset:33920
    ds_read_b64_tr_b16 a[220:221], v9 offset:33952
    ds_read_b64_tr_b16 a[236:237], v9 offset:33984
    ds_read_b64_tr_b16 a[252:253], v9 offset:34016
    ds_read_b64_tr_b16 a[128:129], v9 offset:50688
    ds_read_b64_tr_b16 a[144:145], v9 offset:50720
    ds_read_b64_tr_b16 a[160:161], v9 offset:50752
    ds_read_b64_tr_b16 a[176:177], v9 offset:50784
    ds_read_b64_tr_b16 a[192:193], v9 offset:50816
    ds_read_b64_tr_b16 a[208:209], v9 offset:50848
    ds_read_b64_tr_b16 a[224:225], v9 offset:50880
    ds_read_b64_tr_b16 a[240:241], v9 offset:50912
L_pv_31:
    s_waitcnt lgkmcnt(0) vmcnt(8)
    s_barrier
    s_lshl_b32 s30, s54, 5
    s_add_u32 s30, s30, s3
    s_lshl_b32 s30, s30, 15
    s_lshl_b32 s59, s53, 8
    s_add_u32 s30, s30, s59
    s_lshl_b32 s31, s3, 10
    buffer_load_dword v81, v80, s[44:47], s4 offen sc1
L_late_34_r:
    s_lshr_b32 s61, s3, 1
    s_cmp_lg_u32 s61, 0
    s_cbranch_scc1 L_nq_36
    ds_read_b128 a[64:67], v62 offset:0
    ds_read_b128 a[68:71], v62 offset:64
    ds_read_b128 a[72:75], v62 offset:128
    ds_read_b128 a[76:79], v62 offset:192
    ds_read_b128 a[80:83], v62 offset:256
    ds_read_b128 a[84:87], v62 offset:320
    ds_read_b128 a[88:91], v62 offset:384
    ds_read_b128 a[92:95], v62 offset:448
    ds_read_b128 a[96:99], v62 offset:512
    ds_read_b128 a[100:103], v62 offset:576
    ds_read_b128 a[104:107], v62 offset:640
    ds_read_b128 a[108:111], v62 offset:704
    ds_read_b128 a[112:115], v62 offset:768
    ds_read_b128 a[116:119], v62 offset:832
    ds_read_b128 a[120:123], v62 offset:896
    ds_read_b128 a[124:127], v62 offset:960
L_nq_36:
    s_cmp_lg_u32 s3, 0
    s_cbranch_scc1 L_pv_37
    ds_read_b64_tr_b16 a[130:131], v10 offset:0
    ds_read_b64_tr_b16 a[146:147], v10 offset:32
    ds_read_b64_tr_b16 a[162:163], v10 offset:64
    ds_read_b64_tr_b16 a[178:179], v10 offset:96
    ds_read_b64_tr_b16 a[194:195], v10 offset:128
    ds_read_b64_tr_b16 a[210:211], v10 offset:160
    ds_read_b64_tr_b16 a[226:227], v10 offset:192
    ds_read_b64_tr_b16 a[242:243], v10 offset:224
    ds_read_b64_tr_b16 a[134:135], v10 offset:16896
    ds_read_b64_tr_b16 a[150:151], v10 offset:16928
    ds_read_b64_tr_b16 a[166:167], v10 offset:16960
    ds_read_b64_tr_b16 a[182:183], v10 offset:16992
    ds_read_b64_tr_b16 a[198:199], v10 offset:17024
    ds_read_b64_tr_b16 a[214:215], v10 offset:17056
    ds_read_b64_tr_b16 a[230:231], v10 offset:17088
    ds_read_b64_tr_b16 a[246:247], v10 offset:17120
L_pv_37:
    s_cmp_lg_u32 s3, 1
    s_cbranch_scc1 L_pv_38
    ds_read_b64_tr_b16 a[142:143], v10 offset:0
    ds_read_b64_tr_b16 a[158:159], v10 offset:32
    ds_read_b64_tr_b16 a[174:175], v10 offset:64
    ds_read_b64_tr_b16 a[190:191], v10 offset:96
    ds_read_b64_tr_b16 a[206:207], v10 offset:128
    ds_read_b64_tr_b16 a[222:223], v10 offset:160
    ds_read_b64_tr_b16 a[238:239], v10 offset:192
    ds_read_b64_tr_b16 a[254:255], v10 offset:224
    ds_read_b64_tr_b16 a[130:131], v10 offset:16896
    ds_read_b64_tr_b16 a[146:147], v10 offset:16928
    ds_read_b64_tr_b16 a[162:163], v10 offset:16960
    ds_read_b64_tr_b16 a[178:179], v10 offset:16992
    ds_read_b64_tr_b16 a[194:195], v10 offset:17024
    ds_read_b64_tr_b16 a[210:211], v10 offset:17056
    ds_read_b64_tr_b16 a[226:227], v10 offset:17088
    ds_read_b64_tr_b16 a[242:243], v10 offset:17120
L_pv_38:
    s_cmp_lg_u32 s3, 2
    s_cbranch_scc1 L_pv_39
    ds_read_b64_tr_b16 a[138:139], v10 offset:0
    ds_read_b64_tr_b16 a[154:155], v10 offset:32
    ds_read_b64_tr_b16 a[170:171], v10 offset:64
    ds_read_b64_tr_b16 a[186:187], v10 offset:96
    ds_read_b64_tr_b16 a[202:203], v10 offset:128
    ds_read_b64_tr_b16 a[218:219], v10 offset:160
    ds_read_b64_tr_b16 a[234:235], v10 offset:192
    ds_read_b64_tr_b16 a[250:251], v10 offset:224
    ds_read_b64_tr_b16 a[142:143], v10 offset:16896
    ds_read_b64_tr_b16 a[158:159], v10 offset:16928
    ds_read_b64_tr_b16 a[174:175], v10 offset:16960
    ds_read_b64_tr_b16 a[190:191], v10 offset:16992
    ds_read_b64_tr_b16 a[206:207], v10 offset:17024
    ds_read_b64_tr_b16 a[222:223], v10 offset:17056
    ds_read_b64_tr_b16 a[238:239], v10 offset:17088
    ds_read_b64_tr_b16 a[254:255], v10 offset:17120
L_pv_39:
    s_cmp_lg_u32 s3, 3
    s_cbranch_scc1 L_pv_40
    ds_read_b64_tr_b16 a[134:135], v10 offset:0
    ds_read_b64_tr_b16 a[150:151], v10 offset:32
    ds_read_b64_tr_b16 a[166:167], v10 offset:64
    ds_read_b64_tr_b16 a[182:183], v10 offset:96
    ds_read_b64_tr_b16 a[198:199], v10 offset:128
    ds_read_b64_tr_b16 a[214:215], v10 offset:160
    ds_read_b64_tr_b16 a[230:231], v10 offset:192
    ds_read_b64_tr_b16 a[246:247], v10 offset:224
    ds_read_b64_tr_b16 a[138:139], v10 offset:16896
    ds_read_b64_tr_b16 a[154:155], v10 offset:16928
    ds_read_b64_tr_b16 a[170:171], v10 offset:16960
    ds_read_b64_tr_b16 a[186:187], v10 offset:16992
    ds_read_b64_tr_b16 a[202:203], v10 offset:17024
    ds_read_b64_tr_b16 a[218:219], v10 offset:17056
    ds_read_b64_tr_b16 a[234:235], v10 offset:17088
    ds_read_b64_tr_b16 a[250:251], v10 offset:17120
L_pv_40:
    s_waitcnt lgkmcnt(0) vmcnt(0)
    s_barrier
    s_mov_b32 s57, 0
    s_branch L_h1_gate_41_w
L_h1_gate_41:
    buffer_load_dword v81, v80, s[44:47], s4 offen sc1
L_h1_gate_41_w:
    s_waitcnt vmcnt(0)
    v_cmp_ne_u32 vcc, s52, v81
    s_cmp_lg_u64 vcc, 0
    s_cbranch_scc0 L_h1_open_42
    s_add_u32 s57, s57, 1
    s_cmp_lt_u32 s57, 1048576
    s_cbranch_scc1 L_h1_gate_41
L_h1_open_42:
    s_add_u32 s60, s100, 0
    s_add_u32 m0, s55, 0
    s_nop 0
    buffer_load_dwordx4 v48, s[44:47], s60 offen sc1 lds
    s_add_u32 m0, s55, 1024
    s_nop 0
    buffer_load_dwordx4 v49, s[44:47], s60 offen sc1 lds
    s_add_u32 m0, s55, 2048
    s_nop 0
    buffer_load_dwordx4 v50, s[44:47], s60 offen sc1 lds
    s_add_u32 s60, s100, 0
    s_add_u32 m0, s55, 3072
    s_nop 0
    buffer_load_dwordx4 v51, s[44:47], s60 offen sc1 lds
    s_add_u32 m0, s55, 4096
    s_nop 0
    buffer_load_dwordx4 v52, s[44:47], s60 offen sc1 lds
    s_add_u32 m0, s55, 5120
    s_nop 0
    buffer_load_dwordx4 v53, s[44:47], s60 offen sc1 lds
    s_lshr_b32 s61, s3, 1
    s_cmp_lg_u32 s61, 1
    s_cbranch_scc1 L_nq_43
    ds_read_b128 a[64:67], v62 offset:0
    ds_read_b128 a[68:71], v62 offset:64
    ds_read_b128 a[72:75], v62 offset:128
    ds_read_b128 a[76:79], v62 offset:192
    ds_read_b128 a[80:83], v62 offset:256
    ds_read_b128 a[84:87], v62 offset:320
    ds_read_b128 a[88:91], v62 offset:384
    ds_read_b128 a[92:95], v62 offset:448
    ds_read_b128 a[96:99], v62 offset:512
    ds_read_b128 a[100:103], v62 offset:576
    ds_read_b128 a[104:107], v62 offset:640
    ds_read_b128 a[108:111], v62 offset:704
    ds_read_b128 a[112:115], v62 offset:768
    ds_read_b128 a[116:119], v62 offset:832
    ds_read_b128 a[120:123], v62 offset:896
    ds_read_b128 a[124:127], v62 offset:960
L_nq_43:
    s_cmp_lg_u32 s3, 0
    s_cbranch_scc1 L_pv_44
    ds_read_b64_tr_b16 a[138:139], v10 offset:33792
    ds_read_b64_tr_b16 a[154:155], v10 offset:33824
    ds_read_b64_tr_b16 a[170:171], v10 offset:33856
    ds_read_b64_tr_b16 a[186:187], v10 offset:33888
    ds_read_b64_tr_b16 a[202:203], v10 offset:33920
    ds_read_b64_tr_b16 a[218:219], v10 offset:33952
    ds_read_b64_tr_b16 a[234:235], v10 offset:33984
    ds_read_b64_tr_b16 a[250:251], v10 offset:34016
    ds_read_b64_tr_b16 a[142:143], v10 offset:50688
    ds_read_b64_tr_b16 a[158:159], v10 offset:50720
    ds_read_b64_tr_b16 a[174:175], v10 offset:50752
    ds_read_b64_tr_b16 a[190:191], v10 offset:50784
    ds_read_b64_tr_b16 a[206:207], v10 offset:50816
    ds_read_b64_tr_b16 a[222:223], v10 offset:50848
    ds_read_b64_tr_b16 a[238:239], v10 offset:50880
    ds_read_b64_tr_b16 a[254:255], v10 offset:50912
L_pv_44:
    s_cmp_lg_u32 s3, 1
    s_cbranch_scc1 L_pv_45
    ds_read_b64_tr_b16 a[134:135], v10 offset:33792
    ds_read_b64_tr_b16 a[150:151], v10 offset:33824
    ds_read_b64_tr_b16 a[166:167], v10 offset:33856
    ds_read_b64_tr_b16 a[182:183], v10 offset:33888
    ds_read_b64_tr_b16 a[198:199], v10 offset:33920
    ds_read_b64_tr_b16 a[214:215], v10 offset:33952
    ds_read_b64_tr_b16 a[230:231], v10 offset:33984
    ds_read_b64_tr_b16 a[246:247], v10 offset:34016
    ds_read_b64_tr_b16 a[138:139], v10 offset:50688
    ds_read_b64_tr_b16 a[154:155], v10 offset:50720
    ds_read_b64_tr_b16 a[170:171], v10 offset:50752
    ds_read_b64_tr_b16 a[186:187], v10 offset:50784
    ds_read_b64_tr_b16 a[202:203], v10 offset:50816
    ds_read_b64_tr_b16 a[218:219], v10 offset:50848
    ds_read_b64_tr_b16 a[234:235], v10 offset:50880
    ds_read_b64_tr_b16 a[250:251], v10 offset:50912
L_pv_45:
    s_cmp_lg_u32 s3, 2
    s_cbranch_scc1 L_pv_46
    ds_read_b64_tr_b16 a[130:131], v10 offset:33792
    ds_read_b64_tr_b16 a[146:147], v10 offset:33824
    ds_read_b64_tr_b16 a[162:163], v10 offset:33856
    ds_read_b64_tr_b16 a[178:179], v10 offset:33888
    ds_read_b64_tr_b16 a[194:195], v10 offset:33920
    ds_read_b64_tr_b16 a[210:211], v10 offset:33952
    ds_read_b64_tr_b16 a[226:227], v10 offset:33984
    ds_read_b64_tr_b16 a[242:243], v10 offset:34016
    ds_read_b64_tr_b16 a[134:135], v10 offset:50688
    ds_read_b64_tr_b16 a[150:151], v10 offset:50720
    ds_read_b64_tr_b16 a[166:167], v10 offset:50752
    ds_read_b64_tr_b16 a[182:183], v10 offset:50784
    ds_read_b64_tr_b16 a[198:199], v10 offset:50816
    ds_read_b64_tr_b16 a[214:215], v10 offset:50848
    ds_read_b64_tr_b16 a[230:231], v10 offset:50880
    ds_read_b64_tr_b16 a[246:247], v10 offset:50912
L_pv_46:
    s_cmp_lg_u32 s3, 3
    s_cbranch_scc1 L_pv_47
    ds_read_b64_tr_b16 a[142:143], v10 offset:33792
    ds_read_b64_tr_b16 a[158:159], v10 offset:33824
    ds_read_b64_tr_b16 a[174:175], v10 offset:33856
    ds_read_b64_tr_b16 a[190:191], v10 offset:33888
    ds_read_b64_tr_b16 a[206:207], v10 offset:33920
    ds_read_b64_tr_b16 a[222:223], v10 offset:33952
    ds_read_b64_tr_b16 a[238:239], v10 offset:33984
    ds_read_b64_tr_b16 a[254:255], v10 offset:34016
    ds_read_b64_tr_b16 a[130:131], v10 offset:50688
    ds_read_b64_tr_b16 a[146:147], v10 offset:50720
    ds_read_b64_tr_b16 a[162:163], v10 offset:50752
    ds_read_b64_tr_b16 a[178:179], v10 offset:50784
    ds_read_b64_tr_b16 a[194:195], v10 offset:50816
    ds_read_b64_tr_b16 a[210:211], v10 offset:50848
    ds_read_b64_tr_b16 a[226:227], v10 offset:50880
    ds_read_b64_tr_b16 a[242:243], v10 offset:50912
L_pv_47:
L_join_35:
    buffer_load_dword v141, v140, s[36:39], s30 offen
    s_mov_b32 s56, 3
    s_mov_b32 s57, 0
    s_waitcnt vmcnt(4)
    ds_read_b32 v82, v43 offset:0
    ds_read_b32 v83, v43 offset:1024
    ds_read_b32 v84, v43 offset:2048
    s_waitcnt vmcnt(1)
    ds_read_b32 v85, v43 offset:3072
    ds_read_b32 v86, v43 offset:4096
    ds_read_b32 v87, v43 offset:5120
    s_waitcnt lgkmcnt(3)
    v_cmp_eq_u32 s[62:63], s52, v82
    v_cmp_eq_u32 vcc, s52, v83
    s_and_b64 s[62:63], s[62:63], vcc
    v_cmp_eq_u32 vcc, s52, v84
    s_and_b64 s[62:63], s[62:63], vcc
    s_cmp_eq_u64 s[62:63], exec
    s_cselect_b32 s61, 1, 0
    s_andn2_b32 s56, s56, s61
    s_waitcnt lgkmcnt(0)
    v_cmp_eq_u32 s[62:63], s52, v85
    v_cmp_eq_u32 vcc, s52, v86
    s_and_b64 s[62:63], s[62:63], vcc
    v_cmp_eq_u32 vcc, s52, v87
    s_and_b64 s[62:63], s[62:63], vcc
    s_cmp_eq_u64 s[62:63], exec
    s_cselect_b32 s61, 2, 0
    s_andn2_b32 s56, s56, s61
    s_cbranch_scc0 L_h1_done_33
L_h1_poll_32:
    s_bitcmp1_b32 s56, 0
    s_cbranch_scc0 L_sk_48
    s_add_u32 s60, s100, 0
    s_add_u32 m0, s55, 0
    s_nop 0
    buffer_load_dwordx4 v48, s[44:47], s60 offen sc1 lds
    s_add_u32 m0, s55, 1024
    s_nop 0
    buffer_load_dwordx4 v49, s[44:47], s60 offen sc1 lds
    s_add_u32 m0, s55, 2048
    s_nop 0
    buffer_load_dwordx4 v50, s[44:47], s60 offen sc1 lds
L_sk_48:
    s_bitcmp1_b32 s56, 1
    s_cbranch_scc0 L_sk_49
    s_add_u32 s60, s100, 0
    s_add_u32 m0, s55, 3072
    s_nop 0
    buffer_load_dwordx4 v51, s[44:47], s60 offen sc1 lds
    s_add_u32 m0, s55, 4096
    s_nop 0
    buffer_load_dwordx4 v52, s[44:47], s60 offen sc1 lds
    s_add_u32 m0, s55, 5120
    s_nop 0
    buffer_load_dwordx4 v53, s[44:47], s60 offen sc1 lds
L_sk_49:
    s_waitcnt vmcnt(0)
    ds_read_b32 v82, v43 offset:0
    ds_read_b32 v83, v43 offset:1024
    ds_read_b32 v84, v43 offset:2048
    ds_read_b32 v85, v43 offset:3072
    ds_read_b32 v86, v43 offset:4096
    ds_read_b32 v87, v43 offset:5120
    s_waitcnt lgkmcnt(0)
    v_cmp_eq_u32 s[62:63], s52, v82
    v_cmp_eq_u32 vcc, s52, v83
    s_and_b64 s[62:63], s[62:63], vcc
    v_cmp_eq_u32 vcc, s52, v84
    s_and_b64 s[62:63], s[62:63], vcc
    s_cmp_eq_u64 s[62:63], exec
    s_cselect_b32 s61, 1, 0
    s_andn2_b32 s56, s56, s61
    v_cmp_eq_u32 s[62:63], s52, v85
    v_cmp_eq_u32 vcc, s52, v86
    s_and_b64 s[62:63], s[62:63], vcc
    v_cmp_eq_u32 vcc, s52, v87
    s_and_b64 s[62:63], s[62:63], vcc
    s_cmp_eq_u64 s[62:63], exec
    s_cselect_b32 s61, 2, 0
    s_andn2_b32 s56, s56, s61
    s_cbranch_scc0 L_h1_done_33
    s_add_u32 s57, s57, 1
    s_cmp_lt_u32 s57, 1048576
    s_cbranch_scc1 L_h1_poll_32
L_h1_done_33:
    s_waitcnt lgkmcnt(0)
    s_barrier
    ds_read_b64 v[112:113], v44 offset:256
    ds_read_b64 v[114:115], v45 offset:256
    ds_read_b128 v[80:83], v44 offset:0
    ds_read_b128 v[84:87], v45 offset:0
    ds_read_b128 v[88:91], v46 offset:0
    ds_read_b128 v[92:95], v47 offset:0
    ds_read_b64 v[116:117], v46 offset:512
    ds_read_b64 v[118:119], v47 offset:512
    ds_read_b128 v[96:99], v46 offset:256
    ds_read_b128 v[100:103], v47 offset:256
    s_waitcnt lgkmcnt(7)
    v_mov_b32 v83, v112
    s_waitcnt lgkmcnt(6)
    v_mov_b32 v87, v114
    v_mfma_f32_16x16x32_bf16 v[64:67], a[0:3], v[80:83], 0
    ds_read_b128 v[104:107], v44 offset:512
    v_mfma_f32_16x16x32_bf16 v[68:71], a[64:67], v[80:83], 0
    s_waitcnt lgkmcnt(6)
    v_mov_b32 v91, v113
    v_mfma_f32_16x16x32_bf16 v[64:67], a[4:7], v[84:87], v[64:67]
    ds_read_b128 v[80:83], v45 offset:512
    v_mfma_f32_16x16x32_bf16 v[68:71], a[68:71], v[84:87], v[68:71]
    s_waitcnt lgkmcnt(6)
    v_mov_b32 v95, v115
    v_mfma_f32_16x16x32_bf16 v[64:67], a[8:11], v[88:91], v[64:67]
    ds_read_b64 v[120:121], v44 offset:1024
    ds_read_b64 v[122:123], v45 offset:1024
    ds_read_b128 v[84:87], v44 offset:768
    v_mfma_f32_16x16x32_bf16 v[68:71], a[72:75], v[88:91], v[68:71]
    s_waitcnt lgkmcnt(6)
    v_mov_b32 v99, v116
    v_mfma_f32_16x16x32_bf16 v[64:67], a[12:15], v[92:95], v[64:67]
    ds_read_b128 v[88:91], v45 offset:768
    v_mfma_f32_16x16x32_bf16 v[68:71], a[76:79], v[92:95], v[68:71]
    s_waitcnt lgkmcnt(6)
    v_mov_b32 v103, v118
    v_mfma_f32_16x16x32_bf16 v[64:67], a[16:19], v[96:99], v[64:67]
    ds_read_b128 v[92:95], v46 offset:768
    v_mfma_f32_16x16x32_bf16 v[68:71], a[80:83], v[96:99], v[68:71]
    s_waitcnt lgkmcnt(6)
    v_mov_b32 v107, v117
    v_mfma_f32_16x16x32_bf16 v[64:67], a[20:23], v[100:103], v[64:67]
    ds_read_b128 v[96:99], v47 offset:768
    v_mfma_f32_16x16x32_bf16 v[68:71], a[84:87], v[100:103], v[68:71]
    s_waitcnt lgkmcnt(6)
    v_mov_b32 v83, v119
    v_mfma_f32_16x16x32_bf16 v[64:67], a[24:27], v[104:107], v[64:67]
    ds_read_b64 v[124:125], v46 offset:1280
    ds_read_b64 v[126:127], v47 offset:1280
    ds_read_b128 v[100:103], v46 offset:1024
    v_mfma_f32_16x16x32_bf16 v[68:71], a[88:91], v[104:107], v[68:71]
    s_waitcnt lgkmcnt(6)
    v_mov_b32 v87, v120
    v_mfma_f32_16x16x32_bf16 v[64:67], a[28:31], v[80:83], v[64:67]
    ds_read_b128 v[104:107], v47 offset:1024
    v_mfma_f32_16x16x32_bf16 v[68:71], a[92:95], v[80:83], v[68:71]
    s_waitcnt lgkmcnt(6)
    v_mov_b32 v91, v122
    v_mfma_f32_16x16x32_bf16 v[64:67], a[32:35], v[84:87], v[64:67]
    ds_read_b128 v[80:83], v44 offset:1280
    v_mfma_f32_16x16x32_bf16 v[68:71], a[96:99], v[84:87], v[68:71]
    s_waitcnt lgkmcnt(6)
    v_mov_b32 v95, v121
    v_mfma_f32_16x16x32_bf16 v[64:67], a[36:39], v[88:91], v[64:67]
    ds_read_b128 v[84:87], v45 offset:1280
    v_mfma_f32_16x16x32_bf16 v[68:71], a[100:103], v[88:91], v[68:71]
    s_waitcnt lgkmcnt(6)
    v_mov_b32 v99, v123
    v_mfma_f32_16x16x32_bf16 v[64:67], a[40:43], v[92:95], v[64:67]
    v_mfma_f32_16x16x32_bf16 v[68:71], a[104:107], v[92:95], v[68:71]
    s_waitcnt lgkmcnt(3)
    v_mov_b32 v103, v124
    v_mfma_f32_16x16x32_bf16 v[64:67], a[44:47], v[96:99], v[64:67]
    v_mfma_f32_16x16x32_bf16 v[68:71], a[108:111], v[96:99], v[68:71]
    s_waitcnt lgkmcnt(2)
    v_mov_b32 v107, v126
    v_mfma_f32_16x16x32_bf16 v[64:67], a[48:51], v[100:103], v[64:67]
    v_mfma_f32_16x16x32_bf16 v[68:71], a[112:115], v[100:103], v[68:71]
    s_waitcnt lgkmcnt(1)
    v_mov_b32 v83, v125
    v_mfma_f32_16x16x32_bf16 v[64:67], a[52:55], v[104:107], v[64:67]
    v_mfma_f32_16x16x32_bf16 v[68:71], a[116:119], v[104:107], v[68:71]
    s_waitcnt lgkmcnt(0)
    v_mov_b32 v87, v127
    v_mfma_f32_16x16x32_bf16 v[64:67], a[56:59], v[80:83], v[64:67]
    v_mfma_f32_16x16x32_bf16 v[68:71], a[120:123], v[80:83], v[68:71]
    v_mfma_f32_16x16x32_bf16 v[64:67], a[60:63], v[84:87], v[64:67]
    v_mfma_f32_16x16x32_bf16 v[68:71], a[124:127], v[84:87], v[68:71]
    s_add_u32 s58, s101, 98304
    s_add_u32 s59, s101, 196608
    s_add_u32 s60, s101, 294912
    s_nop 3
    v_max3_f32 v30, v64, v65, v66
    v_max3_f32 v31, v68, v69, v70
    v_max3_f32 v30, v30, v67, v71
    v_max_f32 v30, v30, v31
    v_mov_b32 v31, v30
    s_nop 1
    v_permlane16_swap_b32 v30, v31
    v_max_f32 v30, v30, v31
    v_mov_b32 v31, v30
    s_nop 1
    v_permlane32_swap_b32 v30, v31
    v_max_f32 v30, v30, v31
    ds_write_b32 v15, v30
    s_waitcnt lgkmcnt(0)
    s_barrier
    ds_read_b128 v[20:23], v14
    s_waitcnt lgkmcnt(0)
    v_max3_f32 v30, v20, v21, v22
    v_max_f32 v30, v30, v23
    v_sub_f32 v64, v64, v30
    v_sub_f32 v65, v65, v30
    v_exp_f32 v64, v64
    v_sub_f32 v66, v66, v30
    v_exp_f32 v65, v65
    v_sub_f32 v67, v67, v30
    v_exp_f32 v66, v66
    v_cvt_pk_bf16_f32 v96, v64, v65
    v_sub_f32 v68, v68, v30
    v_exp_f32 v67, v67
    v_sub_f32 v69, v69, v30
    v_exp_f32 v68, v68
    v_cvt_pk_bf16_f32 v97, v66, v67
    v_sub_f32 v70, v70, v30
    v_exp_f32 v69, v69
    v_sub_f32 v71, v71, v30
    v_exp_f32 v70, v70
    v_cvt_pk_bf16_f32 v98, v68, v69
    v_exp_f32 v71, v71
    ds_bpermute_b32 v26, v7, v30
    v_cvt_pk_bf16_f32 v99, v70, v71
    ds_write_b128 v16, v[96:99]
    ds_bpermute_b32 v27, v7, v30 offset:8
    v_mfma_f32_16x16x32_bf16 v[192:195], v[96:99], a[128:131], 0
    v_mfma_f32_16x16x32_bf16 v[196:199], v[96:99], a[144:147], 0
    s_waitcnt lgkmcnt(0)
    s_barrier
    ds_read_b128 v[100:103], v17
    ds_read_b128 v[104:107], v18
    ds_read_b128 v[108:111], v19
    v_mfma_f32_16x16x32_bf16 v[200:203], v[96:99], a[160:163], 0
    s_bfe_u32 s61, s2, 0x30004
    s_cmp_lg_u32 s61, 0
    s_cbranch_scc1 L_h2h_50
    s_cmp_lg_u32 s3, 0
    s_cbranch_scc1 L_hint_51
    s_mov_b64 exec, 1
    buffer_store_dword v147, v138, s[44:47], s16 offen sc1
    s_mov_b64 exec, -1
L_hint_51:
L_h2h_50:
    v_mfma_f32_16x16x32_bf16 v[204:207], v[96:99], a[176:179], 0
    v_mfma_f32_16x16x32_bf16 v[208:211], v[96:99], a[192:195], 0
    v_mfma_f32_16x16x32_bf16 v[212:215], v[96:99], a[208:211], 0
    s_waitcnt lgkmcnt(2)
    v_mfma_f32_16x16x32_bf16 v[192:195], v[100:103], a[132:135], v[192:195]
    s_waitcnt lgkmcnt(1)
    v_mfma_f32_16x16x32_bf16 v[192:195], v[104:107], a[136:139], v[192:195]
    s_waitcnt lgkmcnt(0)
    v_mfma_f32_16x16x32_bf16 v[192:195], v[108:111], a[140:143], v[192:195]
    v_mfma_f32_16x16x32_bf16 v[196:199], v[100:103], a[148:151], v[196:199]
    v_mfma_f32_16x16x32_bf16 v[196:199], v[104:107], a[152:155], v[196:199]
    v_mfma_f32_16x16x32_bf16 v[196:199], v[108:111], a[156:159], v[196:199]
    v_mfma_f32_16x16x32_bf16 v[200:203], v[100:103], a[164:167], v[200:203]
    v_mfma_f32_16x16x32_bf16 v[200:203], v[104:107], a[168:171], v[200:203]
    v_mfma_f32_16x16x32_bf16 v[200:203], v[108:111], a[172:175], v[200:203]
    v_mfma_f32_16x16x32_bf16 v[204:207], v[100:103], a[180:183], v[204:207]
    s_nop 3
    v_cvt_pk_bf16_f32 v144, v192, v196
    v_cvt_pk_bf16_f32 v148, v193, v197
    v_mfma_f32_16x16x32_bf16 v[204:207], v[104:107], a[184:187], v[204:207]
    v_cvt_pk_bf16_f32 v152, v194, v198
    v_cvt_pk_bf16_f32 v156, v195, v199
    v_mfma_f32_16x16x32_bf16 v[204:207], v[108:111], a[188:191], v[204:207]
    v_mfma_f32_16x16x32_bf16 v[208:211], v[100:103], a[196:199], v[208:211]
    v_mfma_f32_16x16x32_bf16 v[208:211], v[104:107], a[200:203], v[208:211]
    v_mfma_f32_16x16x32_bf16 v[208:211], v[108:111], a[204:207], v[208:211]
    v_mfma_f32_16x16x32_bf16 v[212:215], v[100:103], a[212:215], v[212:215]
    s_nop 3
    v_cvt_pk_bf16_f32 v145, v200, v204
    v_cvt_pk_bf16_f32 v149, v201, v205
    v_mfma_f32_16x16x32_bf16 v[212:215], v[104:107], a[216:219], v[212:215]
    v_cvt_pk_bf16_f32 v153, v202, v206
    v_cvt_pk_bf16_f32 v157, v203, v207
    v_mfma_f32_16x16x32_bf16 v[212:215], v[108:111], a[220:223], v[212:215]
    v_mfma_f32_16x16x32_bf16 v[172:175], v[96:99], v[168:171], 0
    v_mfma_f32_16x16x32_bf16 v[172:175], v[100:103], v[168:171], v[172:175]
    v_mfma_f32_16x16x32_bf16 v[172:175], v[104:107], v[168:171], v[172:175]
    v_mfma_f32_16x16x32_bf16 v[172:175], v[108:111], v[168:171], v[172:175]
    s_nop 3
    v_cvt_pk_bf16_f32 v146, v208, v212
    buffer_store_dwordx4 v[144:147], v11, s[44:47], s101 offen sc1
    v_mfma_f32_16x16x32_bf16 v[216:219], v[96:99], a[224:227], 0
    v_cvt_pk_bf16_f32 v150, v209, v213
    buffer_store_dwordx4 v[148:151], v11, s[44:47], s58 offen sc1
    v_mfma_f32_16x16x32_bf16 v[216:219], v[100:103], a[228:231], v[216:219]
    v_cvt_pk_bf16_f32 v154, v210, v214
    buffer_store_dwordx4 v[152:155], v11, s[44:47], s59 offen sc1
    v_mfma_f32_16x16x32_bf16 v[216:219], v[104:107], a[232:235], v[216:219]
    v_cvt_pk_bf16_f32 v158, v211, v215
    buffer_store_dwordx4 v[156:159], v11, s[44:47], s60 offen sc1
    v_mfma_f32_16x16x32_bf16 v[216:219], v[108:111], a[236:239], v[216:219]
    v_cndmask_b32 v34, v172, v173, s[98:99]
    v_cvt_pk_bf16_f32 v35, v34, v34
    v_mfma_f32_16x16x32_bf16 v[220:223], v[96:99], a[240:243], 0
    v_lshlrev_b32 v35, 16, v35
    v_sub_f32 v35, v34, v35
    v_mfma_f32_16x16x32_bf16 v[220:223], v[100:103], a[244:247], v[220:223]
    v_cvt_pk_bf16_f32 v34, v34, v35
    v_cndmask_b32 v162, v26, v34, s[96:97]
    v_mfma_f32_16x16x32_bf16 v[220:223], v[104:107], a[248:251], v[220:223]
    v_cndmask_b32 v34, v174, v175, s[98:99]
    v_cvt_pk_bf16_f32 v35, v34, v34
    v_mfma_f32_16x16x32_bf16 v[220:223], v[108:111], a[252:255], v[220:223]
    v_lshlrev_b32 v35, 16, v35
    v_sub_f32 v35, v34, v35
    v_cvt_pk_bf16_f32 v34, v34, v35
    v_cndmask_b32 v166, v27, v34, s[96:97]
    s_nop 3
    v_cvt_pk_bf16_f32 v160, v216, v220
    v_cvt_pk_bf16_f32 v161, v217, v221
    v_cvt_pk_bf16_f32 v164, v218, v222
    v_cvt_pk_bf16_f32 v165, v219, v223
    v_mov_b32 v32, v160
    v_mov_b32 v33, v164
    v_mov_b32_dpp v160, v161 row_ror:8 row_mask:0xf bank_mask:0xc
    v_mov_b32_dpp v164, v165 row_ror:8 row_mask:0xf bank_mask:0xc
    v_mov_b32_dpp v161, v32 row_ror:8 row_mask:0xf bank_mask:0x3
    buffer_store_dwordx4 v[160:163], v12, s[44:47], s101 offen sc1
    v_mov_b32_dpp v165, v33 row_ror:8 row_mask:0xf bank_mask:0x3
    buffer_store_dwordx4 v[164:167], v12, s[44:47], s59 offen sc1
    s_lshl_b32 s58, s53, 2
    s_add_u32 s58, s58, s54
    s_lshl_b32 s58, s58, 2
    s_add_u32 s58, s58, s3
    s_lshl_b32 s100, s58, 8
    s_add_u32 s100, s100, 786432
    s_mul_i32 s58, s58, 6144
    s_add_u32 s58, s58, 1015808
    v_mov_b32 v70, 0
    v_mov_b32 v71, s52
    s_mov_b32 s57, 0
L_h2_gate_52:
    buffer_load_dword v139, v137, s[44:47], s17 offen sc1
L_h2_gate_52_w:
    s_waitcnt vmcnt(0)
    v_cmp_ne_u32 vcc, s52, v139
    s_cmp_lg_u64 vcc, 0
    s_cbranch_scc0 L_h2_open_53
    s_add_u32 s57, s57, 1
    s_cmp_lt_u32 s57, 1048576
    s_cbranch_scc1 L_h2_gate_52
L_h2_open_53:
    s_waitcnt lgkmcnt(0) vmcnt(0)
    s_barrier
    s_add_u32 s60, s58, 0
    s_add_u32 m0, s55, 0
    s_nop 0
    buffer_load_dwordx4 v54, s[44:47], s60 offen sc1 lds
    s_add_u32 m0, s55, 1024
    s_nop 0
    buffer_load_dwordx4 v55, s[44:47], s60 offen sc1 lds
    s_add_u32 m0, s55, 2048
    s_nop 0
    buffer_load_dwordx4 v56, s[44:47], s60 offen sc1 lds
    s_add_u32 s60, s58, 3072
    s_add_u32 m0, s55, 3072
    s_nop 0
    buffer_load_dwordx4 v54, s[44:47], s60 offen sc1 lds
    s_add_u32 m0, s55, 4096
    s_nop 0
    buffer_load_dwordx4 v55, s[44:47], s60 offen sc1 lds
    s_add_u32 m0, s55, 5120
    s_nop 0
    buffer_load_dwordx4 v56, s[44:47], s60 offen sc1 lds
    s_mul_i32 s59, s3, -32704
    s_add_u32 s30, s30, s59
    s_lshl_b32 s31, s3, 13
    s_mov_b32 m0, s31
    s_add_u32 s31, s31, 1024
    buffer_load_dwordx4 v13, s[36:39], s30 offen nt lds
    s_add_u32 s30, s30, 131072
    s_mov_b32 m0, s31
    s_add_u32 s31, s31, 1024
    buffer_load_dwordx4 v13, s[36:39], s30 offen nt lds
    s_add_u32 s30, s30, 131072
    s_mov_b32 m0, s31
    s_add_u32 s31, s31, 1024
    buffer_load_dwordx4 v13, s[36:39], s30 offen nt lds
    s_add_u32 s30, s30, 131072
    s_mov_b32 m0, s31
    s_add_u32 s31, s31, 1024
    buffer_load_dwordx4 v13, s[36:39], s30 offen nt lds
    s_add_u32 s30, s30, 131072
    s_mov_b32 m0, s31
    s_add_u32 s31, s31, 1024
    buffer_load_dwordx4 v13, s[36:39], s30 offen nt lds
    s_add_u32 s30, s30, 131072
    s_mov_b32 m0, s31
    s_add_u32 s31, s31, 1024
    buffer_load_dwordx4 v13, s[36:39], s30 offen nt lds
    s_add_u32 s30, s30, 131072
    s_mov_b32 m0, s31
    s_add_u32 s31, s31, 1024
    buffer_load_dwordx4 v13, s[36:39], s30 offen nt lds
    s_add_u32 s30, s30, 131072
    s_mov_b32 m0, s31
    s_add_u32 s31, s31, 1024
    buffer_load_dwordx4 v13, s[36:39], s30 offen nt lds
    s_add_u32 s30, s30, 131072
    s_mov_b32 s56, 3
    s_mov_b32 s57, 0
    s_waitcnt vmcnt(11)
    ds_read_b32 v80, v43 offset:0
    ds_read_b32 v81, v43 offset:1024
    ds_read_b32 v82, v43 offset:2048
    s_waitcnt vmcnt(8)
    ds_read_b32 v83, v43 offset:3072
    ds_read_b32 v84, v43 offset:4096
    ds_read_b32 v85, v43 offset:5120
    s_waitcnt lgkmcnt(3)
    v_cmp_eq_u32 s[62:63], s52, v80
    v_cmp_eq_u32 vcc, s52, v81
    s_and_b64 s[62:63], s[62:63], vcc
    v_cmp_eq_u32 vcc, s52, v82
    s_and_b64 s[62:63], s[62:63], vcc
    s_cmp_eq_u64 s[62:63], exec
    s_cselect_b32 s61, 1, 0
    s_andn2_b32 s56, s56, s61
    s_waitcnt lgkmcnt(0)
    v_cmp_eq_u32 s[62:63], s52, v83
    v_cmp_eq_u32 vcc, s52, v84
    s_and_b64 s[62:63], s[62:63], vcc
    v_cmp_eq_u32 vcc, s52, v85
    s_and_b64 s[62:63], s[62:63], vcc
    s_cmp_eq_u64 s[62:63], exec
    s_cselect_b32 s61, 2, 0
    s_andn2_b32 s56, s56, s61
    s_cbranch_scc0 L_h2_done_55
L_h2_poll_54:
    s_bitcmp1_b32 s56, 0
    s_cbranch_scc0 L_sk_56
    s_add_u32 s60, s58, 0
    s_add_u32 m0, s55, 0
    s_nop 0
    buffer_load_dwordx4 v54, s[44:47], s60 offen sc1 lds
    s_add_u32 m0, s55, 1024
    s_nop 0
    buffer_load_dwordx4 v55, s[44:47], s60 offen sc1 lds
    s_add_u32 m0, s55, 2048
    s_nop 0
    buffer_load_dwordx4 v56, s[44:47], s60 offen sc1 lds
L_sk_56:
    s_bitcmp1_b32 s56, 1
    s_cbranch_scc0 L_sk_57
    s_add_u32 s60, s58, 3072
    s_add_u32 m0, s55, 3072
    s_nop 0
    buffer_load_dwordx4 v54, s[44:47], s60 offen sc1 lds
    s_add_u32 m0, s55, 4096
    s_nop 0
    buffer_load_dwordx4 v55, s[44:47], s60 offen sc1 lds
    s_add_u32 m0, s55, 5120
    s_nop 0
    buffer_load_dwordx4 v56, s[44:47], s60 offen sc1 lds
L_sk_57:
    s_waitcnt vmcnt(0)
    ds_read_b32 v80, v43 offset:0
    ds_read_b32 v81, v43 offset:1024
    ds_read_b32 v82, v43 offset:2048
    ds_read_b32 v83, v43 offset:3072
    ds_read_b32 v84, v43 offset:4096
    ds_read_b32 v85, v43 offset:5120
    s_waitcnt lgkmcnt(0)
    v_cmp_eq_u32 s[62:63], s52, v80
    v_cmp_eq_u32 vcc, s52, v81
    s_and_b64 s[62:63], s[62:63], vcc
    v_cmp_eq_u32 vcc, s52, v82
    s_and_b64 s[62:63], s[62:63], vcc
    s_cmp_eq_u64 s[62:63], exec
    s_cselect_b32 s61, 1, 0
    s_andn2_b32 s56, s56, s61
    v_cmp_eq_u32 s[62:63], s52, v83
    v_cmp_eq_u32 vcc, s52, v84
    s_and_b64 s[62:63], s[62:63], vcc
    v_cmp_eq_u32 vcc, s52, v85
    s_and_b64 s[62:63], s[62:63], vcc
    s_cmp_eq_u64 s[62:63], exec
    s_cselect_b32 s61, 2, 0
    s_andn2_b32 s56, s56, s61
    s_cbranch_scc0 L_h2_done_55
    s_add_u32 s57, s57, 1
    s_cmp_lt_u32 s57, 1048576
    s_cbranch_scc1 L_h2_poll_54
L_h2_done_55:
    s_waitcnt lgkmcnt(0)
    s_barrier
    s_cmp_lg_u32 s2, 132
    s_cbranch_scc1 L_epoch_58
    s_cmp_lg_u32 s3, 3
    s_cbranch_scc1 L_hint_59
    s_mov_b64 exec, 1
    buffer_store_dword v71, v138, s[44:47], s17 offen sc1
    s_mov_b64 exec, -1
L_hint_59:
L_epoch_58:
    ds_read_b32 v26, v57
    ds_read_b64_tr_b16 v[96:97], v128 offset:0
    ds_read_b64_tr_b16 v[98:99], v128 offset:6144
    ds_read_b64_tr_b16 v[100:101], v129 offset:0
    ds_read_b64_tr_b16 v[102:103], v129 offset:6144
    ds_read_b64_tr_b16 v[104:105], v130 offset:0
    ds_read_b64_tr_b16 v[106:107], v130 offset:6144
    ds_read_b64_tr_b16 v[108:109], v128 offset:12288
    ds_read_b64_tr_b16 v[110:111], v128 offset:18432
    ds_read_b64_tr_b16 v[112:113], v129 offset:12288
    ds_read_b64_tr_b16 v[114:115], v129 offset:18432
    ds_read_b64_tr_b16 v[116:117], v130 offset:12288
    ds_read_b64_tr_b16 v[118:119], v130 offset:18432
    s_waitcnt lgkmcnt(12)
    v_mov_b32 v24, v26
    s_nop 1
    v_max_f32_dpp v24, v24, v24 row_ror:8 row_mask:0xf bank_mask:0xf
    s_nop 1
    v_max_f32_dpp v24, v24, v24 row_ror:4 row_mask:0xf bank_mask:0xf
    s_nop 1
    v_max_f32_dpp v24, v24, v24 row_ror:2 row_mask:0xf bank_mask:0xf
    s_nop 1
    v_max_f32_dpp v24, v24, v24 row_ror:1 row_mask:0xf bank_mask:0xf
    v_mov_b32 v25, v24
    s_nop 1
    v_permlane16_swap_b32 v24, v25
    v_max_f32 v24, v24, v25
    v_mov_b32 v25, v24
    s_nop 1
    v_permlane32_swap_b32 v24, v25
    v_max_f32 v24, v24, v25
    v_sub_f32 v26, v26, v24
    v_exp_f32 v26, v26
    s_nop 0
    v_cvt_pk_bf16_f32 v26, v26, v26
    ds_write_b16 v58, v26
    ds_read_b128 v[80:83], v59
    ds_read_b128 v[84:87], v59 offset:64
    s_waitcnt lgkmcnt(1)
    v_mfma_f32_16x16x32_bf16 v[144:147], v[80:83], v[96:99], 0
    v_mfma_f32_16x16x32_bf16 v[148:151], v[80:83], v[100:103], 0
    v_mfma_f32_16x16x32_bf16 v[152:155], v[80:83], v[104:107], 0
    s_waitcnt lgkmcnt(0)
    v_mfma_f32_16x16x32_bf16 v[144:147], v[84:87], v[108:111], v[144:147]
    v_mfma_f32_16x16x32_bf16 v[148:151], v[84:87], v[112:115], v[148:151]
    v_mfma_f32_16x16x32_bf16 v[152:155], v[84:87], v[116:119], v[152:155]
    s_waitcnt vmcnt(0)
    ds_read_b64_tr_b16 v[224:225], v36 offset:0
    ds_read_b64_tr_b16 v[240:241], v37 offset:0
    ds_read_b64_tr_b16 v[226:227], v36 offset:1024
    ds_read_b64_tr_b16 v[242:243], v37 offset:1024
    ds_read_b64_tr_b16 v[228:229], v36 offset:2048
    ds_read_b64_tr_b16 v[244:245], v37 offset:2048
    ds_read_b64_tr_b16 v[230:231], v36 offset:3072
    ds_read_b64_tr_b16 v[246:247], v37 offset:3072
    ds_read_b64_tr_b16 v[232:233], v36 offset:4096
    ds_read_b64_tr_b16 v[248:249], v37 offset:4096
    ds_read_b64_tr_b16 v[234:235], v36 offset:5120
    ds_read_b64_tr_b16 v[250:251], v37 offset:5120
    ds_read_b64_tr_b16 v[236:237], v36 offset:6144
    ds_read_b64_tr_b16 v[252:253], v37 offset:6144
    ds_read_b64_tr_b16 v[238:239], v36 offset:7168
    ds_read_b64_tr_b16 v[254:255], v37 offset:7168
    s_mov_b64 exec, 0xffff
    v_cvt_pk_bf16_f32 v88, v144, v148
    ds_write_b16 v131, v88
    ds_write_b16_d16_hi v132, v88
    v_cvt_pk_bf16_f32 v89, v152, v152
    ds_write_b16 v133, v89
    ds_write_b32 v134, v152
    s_mov_b64 exec, -1
    s_waitcnt lgkmcnt(0)
    s_barrier
    ds_read_b128 v[96:99], v135 offset:0
    ds_read_b128 v[100:103], v135 offset:64
    ds_read_b128 v[104:107], v135 offset:128
    ds_read_b128 v[108:111], v135 offset:192
    ds_read_b64 v[26:27], v136
    s_waitcnt lgkmcnt(4)
    v_mfma_f32_16x16x32_bf16 v[72:75], v[96:99], v[224:227], 0
    v_mfma_f32_16x16x32_bf16 v[76:79], v[96:99], v[240:243], 0
    s_waitcnt lgkmcnt(3)
    v_mfma_f32_16x16x32_bf16 v[72:75], v[100:103], v[228:231], v[72:75]
    v_mfma_f32_16x16x32_bf16 v[76:79], v[100:103], v[244:247], v[76:79]
    s_waitcnt lgkmcnt(2)
    v_mfma_f32_16x16x32_bf16 v[72:75], v[104:107], v[232:235], v[72:75]
    v_mfma_f32_16x16x32_bf16 v[76:79], v[104:107], v[248:251], v[76:79]
    s_waitcnt lgkmcnt(1)
    v_mfma_f32_16x16x32_bf16 v[72:75], v[108:111], v[236:239], v[72:75]
    v_mfma_f32_16x16x32_bf16 v[76:79], v[108:111], v[252:255], v[76:79]
    s_waitcnt lgkmcnt(0)
    v_add_f32 v26, v26, v27
    v_rcp_f32 v26, v26
    s_nop 3
    v_mul_f32 v72, v72, v26
    v_mul_f32 v76, v76, v26
    s_mov_b64 exec, 0xffff
    v_mov_b32 v68, v72
    v_mov_b32 v69, v76
    s_add_u32 s61, s100, 4194304
    buffer_store_dwordx4 v[68:71], v6, s[44:47], s61 offen
    buffer_store_dwordx4 v[68:71], v6, s[44:47], s100 offen sc1
    s_mov_b64 exec, -1
    s_cmp_ge_u32 s2, 176
    s_cbranch_scc1 L_exit
    s_sub_u32 s4, s2, 128
    s_lshr_b32 s58, s4, 2
    s_mul_i32 s59, s58, 43
    s_lshr_b32 s59, s59, 7
    s_mul_i32 s60, s59, 3
    s_sub_u32 s58, s58, s60
    s_and_b32 s60, s4, 3
    s_lshl_b32 s60, s60, 3
    s_lshl_b32 s26, s59, 8
    s_mul_i32 s27, s58, 96
    s_add_u32 s26, s26, s27
    s_add_u32 s26, s26, s60
    s_lshl_b32 s27, s59, 5
    s_add_u32 s27, s27, s60
    s_add_u32 s27, s27, 1024
    s_add_u32 s60, s26, 64
    s_cmp_eq_u32 s58, 2
    s_cselect_b32 s27, s27, s60
    v_lshrrev_b32 v189, 2, v5
    buffer_load_ushort v184, v189, s[48:51], s26 offen
    buffer_load_ushort v185, v189, s[48:51], s26 offen offset:32
    buffer_load_ushort v186, v189, s[48:51], s27 offen
    s_min_u32 s4, s4, 47
    s_mul_i32 s4, s4, 6656
    s_add_u32 s4, s4, 5242880
    s_mul_i32 s59, s3, 1664
    s_add_u32 s4, s4, s59
    v_mul_u32_u24 v187, 64, v4
    v_lshl_add_u32 v187, v5, 1, v187
    v_min_u32 v188, 624, v187
    v_cmp_gt_u32 s[96:97], 40, v1
    s_lshl_b32 s59, s3, 6
    s_add_u32 s59, s59, 159744
    v_add_u32 v9, s59, v6
    v_add_u32 v10, 159744, v6
    s_mov_b32 s32, s24
    s_mov_b32 s33, s25
    s_mov_b32 s34, 1152
    s_mov_b32 s35, 0x20000
    s_waitcnt vmcnt(0)
    v_lshlrev_b32 v28, 16, v184
    v_lshlrev_b32 v29, 16, v185
    v_lshlrev_b32 v30, 16, v186
    s_mov_b32 s57, 0
    buffer_load_dwordx4 v[144:147], v187, s[44:47], s4 offen offset:0 sc1
    buffer_load_dwordx4 v[148:151], v188, s[44:47], s4 offen offset:1024 sc1
L_h3_poll_60:
    buffer_load_dwordx4 v[152:155], v187, s[44:47], s4 offen offset:0 sc1
    buffer_load_dwordx4 v[156:159], v188, s[44:47], s4 offen offset:1024 sc1
    s_waitcnt vmcnt(2)
    v_cmp_eq_u32 s[62:63], s52, v147
    v_cmp_eq_u32 vcc, s52, v151
    s_and_b64 s[62:63], s[62:63], vcc
    s_cmp_eq_u64 s[62:63], exec
    s_cbranch_scc1 L_h3_join_61_0
    buffer_load_dwordx4 v[144:147], v187, s[44:47], s4 offen offset:0 sc1
    buffer_load_dwordx4 v[148:151], v188, s[44:47], s4 offen offset:1024 sc1
    s_waitcnt vmcnt(2)
    v_cmp_eq_u32 s[62:63], s52, v155
    v_cmp_eq_u32 vcc, s52, v159
    s_and_b64 s[62:63], s[62:63], vcc
    s_cmp_eq_u64 s[62:63], exec
    s_cbranch_scc1 L_h3_join_61_1
    s_add_u32 s57, s57, 1
    s_cmp_lt_u32 s57, 1048576
    s_cbranch_scc1 L_h3_poll_60
L_h3_join_61_0:
    v_cndmask_b32 v68, 0, v148, s[96:97]
    v_cndmask_b32 v69, 0, v149, s[96:97]
    v_cndmask_b32 v70, 0, v150, s[96:97]
    v_add_f32 v64, v144, v68
    v_add_f32 v65, v145, v69
    v_add_f32 v66, v146, v70
    s_branch L_h3_join_61
L_h3_join_61_1:
    v_cndmask_b32 v68, 0, v156, s[96:97]
    v_cndmask_b32 v69, 0, v157, s[96:97]
    v_cndmask_b32 v70, 0, v158, s[96:97]
    v_add_f32 v64, v152, v68
    v_add_f32 v65, v153, v69
    v_add_f32 v66, v154, v70
L_h3_join_61:
    v_add_f32_dpp v64, v64, v64 row_ror:4 row_mask:0xf bank_mask:0xf
    v_add_f32_dpp v65, v65, v65 row_ror:4 row_mask:0xf bank_mask:0xf
    v_add_f32_dpp v66, v66, v66 row_ror:4 row_mask:0xf bank_mask:0xf
    v_add_f32_dpp v64, v64, v64 row_ror:8 row_mask:0xf bank_mask:0xf
    v_add_f32_dpp v65, v65, v65 row_ror:8 row_mask:0xf bank_mask:0xf
    v_add_f32_dpp v66, v66, v66 row_ror:8 row_mask:0xf bank_mask:0xf
    v_mov_b32 v68, v64
    v_mov_b32 v69, v65
    v_mov_b32 v70, v66
    v_permlane16_swap_b32 v64, v68
    v_permlane16_swap_b32 v65, v69
    v_permlane16_swap_b32 v66, v70
    v_add_f32 v64, v64, v68
    v_add_f32 v65, v65, v69
    v_add_f32 v66, v66, v70
    v_mov_b32 v68, v64
    v_mov_b32 v69, v65
    v_mov_b32 v70, v66
    v_permlane32_swap_b32 v64, v68
    v_permlane32_swap_b32 v65, v69
    v_permlane32_swap_b32 v66, v70
    v_add_f32 v64, v64, v68
    v_add_f32 v65, v65, v69
    v_add_f32 v66, v66, v70
    s_mov_b64 exec, 15
    ds_write_b128 v9, v[64:67]
    s_waitcnt lgkmcnt(0)
    s_barrier
    s_cmp_lg_u32 s3, 0
    s_cbranch_scc1 L_exit
    ds_read_b128 v[68:71], v10 offset:64
    ds_read_b128 v[72:75], v10 offset:128
    ds_read_b128 v[76:79], v10 offset:192
    v_add_f32 v64, v64, v28
    v_add_f32 v65, v65, v29
    v_add_f32 v66, v66, v30
    s_waitcnt lgkmcnt(2)
    v_add_f32 v64, v64, v68
    v_add_f32 v65, v65, v69
    v_add_f32 v66, v66, v70
    s_waitcnt lgkmcnt(1)
    v_add_f32 v64, v64, v72
    v_add_f32 v65, v65, v73
    v_add_f32 v66, v66, v74
    s_waitcnt lgkmcnt(0)
    v_add_f32 v64, v64, v76
    v_add_f32 v65, v65, v77
    v_add_f32 v66, v66, v78
    v_cvt_pk_bf16_f32 v64, v64, v65
    v_cvt_pk_bf16_f32 v66, v66, v66
    buffer_store_short v64, v189, s[32:35], s26 offen
    buffer_store_short_d16_hi v64, v189, s[32:35], s26 offen offset:32
    buffer_store_short v66, v189, s[32:35], s27 offen
L_exit:
L_end:
    s_endpgm
L_end_of_code:
.section .rodata,"a"
.p2align 6
.amdhsa_kernel parallel_sum__compressed_kv_cla__glu_gated_glu__decode_kernel
  .amdhsa_next_free_vgpr 512
  .amdhsa_next_free_sgpr 102
  .amdhsa_accum_offset 256
  .amdhsa_group_segment_fixed_size 0
  .amdhsa_kernarg_size 104
  .amdhsa_user_sgpr_count 2
  .amdhsa_user_sgpr_kernarg_segment_ptr 1
  .amdhsa_system_sgpr_workgroup_id_x 1
.end_amdhsa_kernel
```
